```python
import torch

def _softmax(x, axis=-1):
    return torch.softmax(x, dim=axis)
def _gelu(x):
    return torch.nn.functional.gelu(x, approximate="tanh")
def _silu(x):
    return torch.nn.functional.silu(x)
def _sigmoid(x):
    return torch.sigmoid(x)
def _layernorm(x, axis=-1, eps=1e-5):
    m = x.mean(dim=axis, keepdim=True)
    v = x.var(dim=axis, keepdim=True, unbiased=False)
    return (x - m) / torch.sqrt(v + eps)
def _scatter_add(tgt, idx, src, axis=0):
    return tgt.clone().index_add_(axis, idx, src)
def _segment_sum(src, seg, n):
    out = torch.zeros((n,) + src.shape[1:], dtype=src.dtype)
    return out.index_add_(0, seg, src)
def _pad(x, pw):
    flat = tuple(v for pair in reversed(pw) for v in pair)
    return torch.nn.functional.pad(x, flat)

kernel_name = 'sequential_preLN__ssm_conv_h3__glu_gated_swiglu__prompt'

def setup_inputs():

    _w = (lambda a: (lambda t: t.to(torch.bfloat16) if t.is_floating_point() else t)(torch.as_tensor(a)))
    def _A_setup():
        B, S, D = 1, 2048, 640
        ks = 4
        return {
            "q": _w((lambda *s: torch.randn(*s, dtype=torch.bfloat16) * 0.05)(B, S, D)),
            "k": _w((lambda *s: torch.randn(*s, dtype=torch.bfloat16) * 0.2)(B, S, D)),
            "v": _w((lambda *s: torch.randn(*s, dtype=torch.bfloat16) * 0.2)(B, S, D)),
            "shift_k": _w((lambda *s: torch.randn(*s, dtype=torch.bfloat16) * 0.2)(D, ks) * 0.5),
            "ssm_k": _w((lambda *s: torch.randn(*s, dtype=torch.bfloat16) * 0.4)(D, S) * (1.0 / S ** 0.5)),
            "ssm_D": _w((lambda *s: torch.randn(*s, dtype=torch.bfloat16) * 0.2)(D)),
        }
    _A_in = _A_setup()

    def _B_setup():
        B, S, D, F = 1, 2048, 640, 1536
        return {
            "x": _w((lambda *s: torch.randn(*s, dtype=torch.bfloat16) * 0.05)(B, S, D)),
            "w1": _w((lambda *s: torch.randn(*s, dtype=torch.bfloat16) * 0.2)(D, F) * (2.0 / D) ** 0.5),
            "w3": _w((lambda *s: torch.randn(*s, dtype=torch.bfloat16) * 0.2)(D, F) * (2.0 / D) ** 0.5),
            "w2": _w((lambda *s: torch.randn(*s, dtype=torch.bfloat16) * 0.2)(F, D) * (2.0 / F) ** 0.5),
        }
    _B_in = _B_setup()

    return {
        "A_q": _A_in["q"],
        "A_k": _A_in["k"],
        "A_v": _A_in["v"],
        "A_shift_k": _A_in["shift_k"],
        "A_ssm_k": _A_in["ssm_k"],
        "A_ssm_D": _A_in["ssm_D"],
        "B_x": _B_in["x"],
        "B_w1": _B_in["w1"],
        "B_w3": _B_in["w3"],
        "B_w2": _B_in["w2"],
    }

def reference(A_q, A_k, A_v, A_shift_k, A_ssm_k, A_ssm_D, B_x, B_w1, B_w3, B_w2):
    def _A_ref(q, k, v, shift_k, ssm_k, ssm_D):
        B, S, D = q.shape
        ks = shift_k.shape[-1]
        k_pad = _pad(k, ((0, 0), (ks - 1, 0), (0, 0)))
        k_shift = torch.zeros_like(k)
        for t in range(ks):
            k_shift = k_shift + k_pad[:, t:t + S, :] * shift_k[:, ks - 1 - t][None, None, :]
        kv = k_shift * v
        L = 2 * S
        kv_pad = _pad(kv, ((0, 0), (0, S), (0, 0)))
        kf_pad = _pad(ssm_k, ((0, 0), (0, S)))
        kv_f = (lambda x, axes=(-2,-1): torch.fft.rfft2(x.float(), dim=axes))(kv_pad[:, None, :, :], axes=(1, 2))
        kf_f = (lambda x, axes=(-2,-1): torch.fft.rfft2(x.float(), dim=axes))(kf_pad[:, None, :], axes=(1, 2))
        kf_f = (lambda x, *d: x.permute(*d))(kf_f, 1, 2, 0)
        y_f = kv_f * kf_f[None, :, :, :]
        y = (lambda x, s, axes=(-2,-1): torch.fft.irfft2(x, s=s, dim=axes).to(torch.bfloat16))(y_f, (1, L), axes=(1, 2))[:, 0, :S, :]
        y = y + kv * ssm_D[None, None, :]
        return q * y

    def _B_ref(x, w1, w3, w2):
        gate = torch.einsum("bsd,df->bsf", x, w1)
        up = torch.einsum("bsd,df->bsf", x, w3)
        h = _silu(gate) * up
        out = torch.einsum("bsf,fd->bsd", h, w2)
        return out

    x = A_q
    h = x + _A_ref(_layernorm(x, axis=-1), A_k, A_v, A_shift_k, A_ssm_k, A_ssm_D)
    h2 = h + _B_ref(_layernorm(h, axis=-1), B_w1, B_w3, B_w2)
    return h2
```

```asm
; @launch grid=(256,1,1) block=(256,1,1) lds=163840
.amdgcn_target "amdgcn-amd-amdhsa--gfx950"
.text
.globl sequential_preLN__ssm_conv_h3__glu_gated_swiglu__prompt_kernel
.p2align 8
.type sequential_preLN__ssm_conv_h3__glu_gated_swiglu__prompt_kernel,@function
sequential_preLN__ssm_conv_h3__glu_gated_swiglu__prompt_kernel:
  s_cmpk_ge_u32 s2, 0x100
  s_cbranch_scc1 L_END
  v_readfirstlane_b32 s3, v0
  s_getpc_b64 s[58:59]
L_PC:
  s_lshr_b32 s49, s2, 3
  s_lshr_b32 s56, s3, 3
  s_load_dwordx2 s[8:9], s[0:1], s56
  s_load_dwordx4 s[12:15], s[0:1], 88
  s_lshl_b32 s57, s49, 8
  v_add_lshl_u32 v2, v0, s57, 3
  v_min_u32 v2, L_LAST-L_PC, v2
  global_load_dword v254, v2, s[58:59]
  s_lshr_b32 s3, s3, 6
  s_and_b32 s48, s2, 7
  v_and_b32 v1, 63, v0
  s_lshl_b32 s50, s48, 5
  s_add_u32 s50, s50, s49
  v_lshlrev_b32 v4, 4, v1
  v_lshrrev_b32 v3, 3, v1
  s_cmp_eq_u32 s3, 3
  s_cbranch_scc1 L_W3
  v_and_b32 v2, 6, v3
  s_mov_b32 s56, 984175872
  s_movk_i32 s57, 0xc0
  v_lshrrev_b32_e64 v2, v2, s56
  v_bitop3_b32 v64, v2, s57, v4 bitop3:0x6a
  v_lshrrev_b32 v2, 8, v2
  v_bitop3_b32 v65, v2, s57, v4 bitop3:0x6a
  v_lshrrev_b32 v2, 8, v2
  v_bitop3_b32 v66, v2, s57, v4 bitop3:0x6a
  v_xor_b32 v67, 0x10c0, v4
  s_min_u32 s10, s50, 1
  s_and_b32 s10, s10, s3
  s_lshl_b32 s56, s50, 1
  s_sub_u32 s56, s56, s10
  s_mul_i32 s57, s3, 3
  s_sub_u32 s57, s57, s10
  s_mulk_i32 s56, 5120
  s_mulk_i32 s57, 5120
  s_add_u32 m0, s57, 92416
  s_waitcnt lgkmcnt(0)
  s_add_u32 s8, s8, s56
  s_addc_u32 s9, s9, 0
L_LD:
  global_load_lds_dwordx4 v4, s[8:9]
  global_load_lds_dwordx4 v64, s[8:9] offset:1024
  global_load_lds_dwordx4 v65, s[8:9] offset:2048
  global_load_lds_dwordx4 v66, s[8:9] offset:3072
  s_addk_i32 m0, 0x1000
  s_addk_i32 s10, -1
  global_load_lds_dwordx4 v67, s[8:9]
  s_addk_i32 m0, 0x400
  s_add_u32 s8, s8, 5120
  s_addc_u32 s9, s9, 0
  s_cmp_gt_i32 s10, -2
  s_cbranch_scc1 L_LD
  s_branch L_COMMON
L_W3:
  s_mov_b32 m0, 118016
  s_cmp_lg_u32 s49, 0
  s_waitcnt lgkmcnt(0)
  s_cbranch_scc1 L_W3B
  v_mov_b32 v204, 0
  v_mov_b32 v205, 0
  v_mov_b32 v206, 0
  v_mov_b32 v207, 0
  v_lshlrev_b32 v3, 10, v3
  v_and_b32 v2, 0x70, v4
  s_lshl_b32 s58, s48, 14
  v_add3_u32 v2, v2, v3, s58
  v_add_u32 v3, 0x2000, v2
  global_store_dwordx4 v2, v[204:207], s[14:15] sc1
  global_store_dwordx4 v3, v[204:207], s[14:15] sc1
L_W3B:
  global_load_lds_dwordx4 v4, s[8:9] offset:0
  global_load_lds_dwordx4 v4, s[8:9] offset:1024
  global_load_lds_dwordx4 v4, s[8:9] offset:2048
  global_load_lds_dwordx4 v4, s[8:9] offset:3072
  s_addk_i32 m0, 0x1000
  v_add_u32 v2, 0x1000, v4
  global_load_lds_dwordx4 v2, s[8:9]
L_COMMON:
  s_load_dwordx2 s[24:25], s[0:1], 32
  s_load_dwordx2 s[6:7], s[0:1], 40
  s_load_dwordx2 s[32:33], s[0:1], 56
  s_load_dwordx2 s[36:37], s[0:1], 64
  s_load_dwordx2 s[40:41], s[0:1], 72
  s_load_dwordx2 s[44:45], s[0:1], 80
  s_mov_b64 s[4:5], s[12:13]
  s_mov_b64 s[20:21], s[14:15]
  s_mov_b32 s22, 33554432
  s_mov_b32 s23, 0x20000
  s_mov_b32 s26, 2621440
  s_mov_b32 s27, 0x20000
  s_mov_b32 s34, 1966080
  s_mov_b32 s35, 0x20000
  s_mov_b32 s38, 1966080
  s_mov_b32 s39, 0x20000
  s_mov_b32 s42, 1966080
  s_mov_b32 s43, 0x20000
  s_mov_b32 s46, 2621440
  s_mov_b32 s47, 0x20000
  v_lshlrev_b32 v53, 4, v0
  v_mov_b32 v7, 1
  v_mov_b32 v204, 0
  v_mov_b32 v205, 0
  v_mov_b32 v206, 0
  v_mov_b32 v207, 0
  s_and_b32 s52, s49, 1
  s_lshr_b32 s56, s49, 1
  s_mul_i32 s56, s56, 5
  s_mul_i32 s51, s48, 80
  s_add_u32 s51, s51, s56
  s_lshl_b32 s56, s52, 1
  s_add_u32 s51, s51, s56
  s_lshr_b32 s53, s48, 2
  s_lshl_b32 s53, s53, 3
  s_lshr_b32 s56, s49, 2
  s_add_u32 s53, s53, s56
  s_and_b32 s54, s48, 3
  s_lshl_b32 s54, s54, 2
  s_and_b32 s56, s49, 3
  s_add_u32 s54, s54, s56
  v_cmp_eq_u32 s[66:67], 0, v0
  s_mul_i32 s56, s50, 10368
  s_add_u32 s63, s56, 4194304
  s_add_u32 s55, s56, 1048576
  v_cmp_gt_u32 vcc, 90, v0
  s_nop 0
  s_and_saveexec_b64 s[64:65], vcc
  ds_write_b128 v53, v[204:207] offset:49920
  s_mov_b64 exec, s[64:65]
  v_lshrrev_b32 v2, 1, v0
  v_mul_u32_u24 v2, 4160, v2
  v_and_b32 v3, 1, v0
  v_lshl_add_u32 v2, v3, 4, v2
  v_cmp_gt_u32 vcc, 24, v0
  s_nop 0
  s_and_saveexec_b64 s[64:65], vcc
  ds_write_b128 v2, v[204:207] offset:4096
  s_mov_b64 exec, s[64:65]
  s_cmp_lg_u32 s50, 0
  s_cbranch_scc1 z_1
  v_add_u32 v2, 102656, v53
  ds_write_b128 v2, v[204:207]
  ds_write_b128 v2, v[204:207] offset:1024
z_1:
  v_bfe_u32 v2, v1, 2, 2
  v_lshrrev_b32 v3, 4, v1
  v_lshlrev_b32 v3, 1, v3
  v_bfe_u32 v98, v1, 1, 1
  v_add_u32 v3, v3, v98
  v_bfe_u32 v98, v0, 6, 1
  v_lshl_add_u32 v3, v98, 3, v3
  v_lshlrev_b32 v98, 2, v2
  v_xor_b32 v3, v3, v98
  v_lshlrev_b32 v3, 4, v3
  v_mul_u32_u24 v2, 1280, v2
  v_add_u32 v3, v3, v2
  v_and_b32 v2, 1, v1
  v_lshl_add_u32 v3, v2, 3, v3
  v_lshrrev_b32 v2, 7, v0
  v_lshl_add_u32 v3, v2, 8, v3
  v_add_u32 v96, 92416, v3
  s_cmp_eq_u32 s3, 2
  s_cselect_b32 s58, 128, 0
  s_movk_i32 s59, 1024
  s_cselect_b32 s59, 512, s59
  s_movk_i32 s73, 0x1000
  s_cselect_b32 s60, 2560, s73
  s_cselect_b32 s73, 1024, s73
  v_xor_b32 v97, s58, v96
  v_add_u32 v97, s59, v97
  v_lshlrev_b32 v209, 3, v0
  v_add_u32 v209, 118016, v209
  v_add_u32 v210, 2048, v209
  v_add_u32 v211, s60, v209
  s_lshl_b32 s56, s53, 4
  s_add_u32 s56, s56, s54
  s_lshl_b32 s56, s56, 9
  s_add_u32 s56, s56, 524288
  s_lshl2_add_u32 s57, s3, s56
  v_and_b32 v2, 3, v1
  v_lshlrev_b32 v40, 7, v2
  v_add_u32 v40, s57, v40
  s_lshl_b32 s57, s3, 7
  s_add_u32 s57, s57, s56
  v_and_b32 v202, 0x70, v4
  v_add_u32 v202, s57, v202
  s_lshl_b32 s58, s48, 8
  s_lshl_b32 s60, s49, 10
  s_add_u32 s58, s58, s60
  s_sub_u32 s59, s48, 1
  s_and_b32 s60, s49, 16
  s_or_b32 s59, s59, s60
  s_lshl_b32 s60, s3, 4
  s_or_b32 s59, s59, s60
  s_cmp_lt_u32 s59, 3
  s_cselect_b32 s58, s58, 0x7ff00000
  v_lshrrev_b32 v2, 3, v1
  v_lshlrev_b32 v98, 14, v2
  v_and_b32 v3, 7, v1
  v_lshl_add_u32 v98, v3, 4, v98
  v_add_u32 v203, s58, v98
  v_mul_u32_u24 v98, 1280, v2
  v_lshl_add_u32 v98, v3, 4, v98
  v_bfe_u32 v99, v1, 4, 1
  v_lshl_add_u32 v98, v99, 7, v98
  v_add_u32 v98, 92416, v98
  v_xor_b32 v208, 128, v98
  s_and_b32 s61, s48, 1
  s_xor_b32 s61, s61, s50
  s_bfe_u32 s60, s61, 0x20002
  v_lshrrev_b32 v99, 2, v2
  v_lshl_add_u32 v99, v3, 1, v99
  v_xor_b32 v99, s60, v99
  v_lshlrev_b32 v99, 4, v99
  v_and_b32 v2, 3, v2
  v_lshl_add_u32 v99, v2, 2, v99
  v_mov_b32 v2, 0x7ffff000
  v_cmp_gt_u32 vcc, 2, v3
  s_nop 1
  v_cndmask_b32 v99, v2, v99, vcc
  s_lshl_b32 s61, s61, 6
  s_add_u32 s62, s61, 262144
  s_waitcnt lgkmcnt(0)
  s_lshr_b32 s58, s51, 1
  s_lshl_b32 s58, s58, 2
  s_load_dwordx2 s[70:71], s[6:7], s58
  s_xor_b32 s61, s3, 3
  s_or_b32 s60, s61, s49
  s_cbranch_scc1 z_2
  v_mov_b32 v2, 0
  s_waitcnt vmcnt(5)
  s_mov_b64 exec, 1
  global_atomic_add v2, v7, s[4:5] sc1
  s_mov_b64 exec, -1
z_2:
  v_subrev_u32 v2, 8, v53
  v_mov_b32 v3, 0x7ffffff0
  v_cndmask_b32 v2, v2, v3, s[66:67]
  s_lshl_b32 s58, s51, 12
  buffer_load_dwordx4 v[80:83], v53, s[24:27], s58 offen
  buffer_load_dwordx2 v[78:79], v2, s[24:27], s58 offen
  s_add_u32 s58, s58, 4096
  buffer_load_dwordx4 v[86:89], v53, s[24:27], s58 offen
  buffer_load_dwordx2 v[84:85], v2, s[24:27], s58 offen
  s_add_u32 s58, s58, 4096
  buffer_load_dwordx4 v[92:95], v53, s[24:27], s58 offen
  buffer_load_dwordx2 v[90:91], v2, s[24:27], s58 offen
  s_waitcnt vmcnt(6)
  s_waitcnt lgkmcnt(0)
  s_barrier
  ds_read_b64 v[72:73], v209
  ds_read_b64_tr_b16 v[100:101], v96 offset:10240
  ds_read_b64_tr_b16 v[102:103], v96 offset:15360
  ds_read_b64_tr_b16 v[104:105], v96 offset:20480
  ds_read_b64_tr_b16 v[106:107], v96 offset:30720
  ds_read_b64_tr_b16 v[108:109], v96 offset:35840
  ds_read_b64_tr_b16 v[112:113], v96 offset:0
  ds_read_b64_tr_b16 v[114:115], v96 offset:5120
  buffer_store_dwordx4 v[204:207], v202, s[20:23], 0 offen sc1
  buffer_store_dwordx4 v[204:207], v203, s[20:23], 0 offen sc1
  s_cmp_eq_u32 s3, 3
  s_cbranch_scc1 st_3
  ds_read_b64 v[74:75], v210
  ds_read_b64_tr_b16 v[116:117], v96 offset:10752
  ds_read_b64_tr_b16 v[118:119], v96 offset:15872
  ds_read_b64_tr_b16 v[120:121], v96 offset:20992
  ds_read_b64_tr_b16 v[122:123], v96 offset:31232
  ds_read_b64_tr_b16 v[124:125], v96 offset:36352
  ds_read_b64_tr_b16 v[128:129], v96 offset:512
  ds_read_b64_tr_b16 v[130:131], v96 offset:5632
  s_waitcnt lgkmcnt(10)
  v_alignbit_b32 v72, v72, v72, 16
  v_alignbit_b32 v73, v73, v73, 16
  v_alignbit_b32 v150, v101, v100, 16
  v_alignbit_b32 v151, v102, v101, 16
  v_alignbit_b32 v152, v103, v102, 16
  v_alignbit_b32 v153, v104, v103, 16
  v_alignbit_b32 v154, v105, v104, 16
  v_dot2_f32_bf16 v159, v101, v73, 0
  v_dot2_f32_bf16 v158, v150, v73, 0
  v_dot2_f32_bf16 v161, v102, v73, 0
  v_dot2_f32_bf16 v160, v151, v73, 0
  v_dot2_f32_bf16 v163, v103, v73, 0
  v_dot2_f32_bf16 v162, v152, v73, 0
  v_dot2_f32_bf16 v165, v104, v73, 0
  v_dot2_f32_bf16 v164, v153, v73, 0
  v_dot2_f32_bf16 v159, v102, v72, v159
  v_dot2_f32_bf16 v158, v151, v72, v158
  v_dot2_f32_bf16 v161, v103, v72, v161
  v_dot2_f32_bf16 v160, v152, v72, v160
  v_dot2_f32_bf16 v163, v104, v72, v163
  v_dot2_f32_bf16 v162, v153, v72, v162
  v_dot2_f32_bf16 v165, v105, v72, v165
  v_dot2_f32_bf16 v164, v154, v72, v164
  s_waitcnt lgkmcnt(8)
  buffer_store_dwordx4 v[112:115], v53, s[20:23], s63 offen sc1
  v_lshlrev_b32 v212, 16, v106
  v_and_b32 v213, 0xffff0000, v106
  v_lshlrev_b32 v214, 16, v107
  v_and_b32 v215, 0xffff0000, v107
  v_lshlrev_b32 v216, 16, v108
  v_and_b32 v217, 0xffff0000, v108
  v_lshlrev_b32 v218, 16, v109
  v_and_b32 v219, 0xffff0000, v109
  v_pk_mul_f32 v[158:159], v[158:159], v[212:213]
  v_pk_mul_f32 v[160:161], v[160:161], v[214:215]
  v_pk_mul_f32 v[162:163], v[162:163], v[216:217]
  v_pk_mul_f32 v[164:165], v[164:165], v[218:219]
  v_cvt_pk_bf16_f32 v168, v158, v159
  v_cvt_pk_bf16_f32 v169, v160, v161
  v_cvt_pk_bf16_f32 v170, v162, v163
  v_cvt_pk_bf16_f32 v171, v164, v165
  buffer_store_dwordx4 v[168:171], v53, s[20:23], s55 offen sc1
  s_add_u32 s55, s55, 4096
  s_add_u32 s63, s63, 4096
  ds_read_b64 v[76:77], v211
  ds_read_b64_tr_b16 v[132:133], v97 offset:10240
  ds_read_b64_tr_b16 v[134:135], v97 offset:15360
  ds_read_b64_tr_b16 v[136:137], v97 offset:20480
  ds_read_b64_tr_b16 v[138:139], v97 offset:30720
  ds_read_b64_tr_b16 v[140:141], v97 offset:35840
  ds_read_b64_tr_b16 v[144:145], v97 offset:0
  ds_read_b64_tr_b16 v[146:147], v97 offset:5120
  s_waitcnt lgkmcnt(10)
  v_alignbit_b32 v74, v74, v74, 16
  v_alignbit_b32 v75, v75, v75, 16
  v_alignbit_b32 v150, v117, v116, 16
  v_alignbit_b32 v151, v118, v117, 16
  v_alignbit_b32 v152, v119, v118, 16
  v_alignbit_b32 v153, v120, v119, 16
  v_alignbit_b32 v154, v121, v120, 16
  v_dot2_f32_bf16 v159, v117, v75, 0
  v_dot2_f32_bf16 v158, v150, v75, 0
  v_dot2_f32_bf16 v161, v118, v75, 0
  v_dot2_f32_bf16 v160, v151, v75, 0
  v_dot2_f32_bf16 v163, v119, v75, 0
  v_dot2_f32_bf16 v162, v152, v75, 0
  v_dot2_f32_bf16 v165, v120, v75, 0
  v_dot2_f32_bf16 v164, v153, v75, 0
  v_dot2_f32_bf16 v159, v118, v74, v159
  v_dot2_f32_bf16 v158, v151, v74, v158
  v_dot2_f32_bf16 v161, v119, v74, v161
  v_dot2_f32_bf16 v160, v152, v74, v160
  v_dot2_f32_bf16 v163, v120, v74, v163
  v_dot2_f32_bf16 v162, v153, v74, v162
  v_dot2_f32_bf16 v165, v121, v74, v165
  v_dot2_f32_bf16 v164, v154, v74, v164
  s_waitcnt lgkmcnt(8)
  buffer_store_dwordx4 v[128:131], v53, s[20:23], s63 offen sc1
  v_lshlrev_b32 v212, 16, v122
  v_and_b32 v213, 0xffff0000, v122
  v_lshlrev_b32 v214, 16, v123
  v_and_b32 v215, 0xffff0000, v123
  v_lshlrev_b32 v216, 16, v124
  v_and_b32 v217, 0xffff0000, v124
  v_lshlrev_b32 v218, 16, v125
  v_and_b32 v219, 0xffff0000, v125
  v_pk_mul_f32 v[158:159], v[158:159], v[212:213]
  v_pk_mul_f32 v[160:161], v[160:161], v[214:215]
  v_pk_mul_f32 v[162:163], v[162:163], v[216:217]
  v_pk_mul_f32 v[164:165], v[164:165], v[218:219]
  v_cvt_pk_bf16_f32 v172, v158, v159
  v_cvt_pk_bf16_f32 v173, v160, v161
  v_cvt_pk_bf16_f32 v174, v162, v163
  v_cvt_pk_bf16_f32 v175, v164, v165
  buffer_store_dwordx4 v[172:175], v53, s[20:23], s55 offen sc1
  s_add_u32 s55, s55, s73
  s_add_u32 s63, s63, s73
  s_waitcnt lgkmcnt(2)
  v_alignbit_b32 v76, v76, v76, 16
  v_alignbit_b32 v77, v77, v77, 16
  v_alignbit_b32 v150, v133, v132, 16
  v_alignbit_b32 v151, v134, v133, 16
  v_alignbit_b32 v152, v135, v134, 16
  v_alignbit_b32 v153, v136, v135, 16
  v_alignbit_b32 v154, v137, v136, 16
  v_dot2_f32_bf16 v159, v133, v77, 0
  v_dot2_f32_bf16 v158, v150, v77, 0
  v_dot2_f32_bf16 v161, v134, v77, 0
  v_dot2_f32_bf16 v160, v151, v77, 0
  v_dot2_f32_bf16 v163, v135, v77, 0
  v_dot2_f32_bf16 v162, v152, v77, 0
  v_dot2_f32_bf16 v165, v136, v77, 0
  v_dot2_f32_bf16 v164, v153, v77, 0
  v_dot2_f32_bf16 v159, v134, v76, v159
  v_dot2_f32_bf16 v158, v151, v76, v158
  v_dot2_f32_bf16 v161, v135, v76, v161
  v_dot2_f32_bf16 v160, v152, v76, v160
  v_dot2_f32_bf16 v163, v136, v76, v163
  v_dot2_f32_bf16 v162, v153, v76, v162
  v_dot2_f32_bf16 v165, v137, v76, v165
  v_dot2_f32_bf16 v164, v154, v76, v164
  s_waitcnt lgkmcnt(0)
  buffer_store_dwordx4 v[144:147], v53, s[20:23], s63 offen sc1
  v_lshlrev_b32 v212, 16, v138
  v_and_b32 v213, 0xffff0000, v138
  v_lshlrev_b32 v214, 16, v139
  v_and_b32 v215, 0xffff0000, v139
  v_lshlrev_b32 v216, 16, v140
  v_and_b32 v217, 0xffff0000, v140
  v_lshlrev_b32 v218, 16, v141
  v_and_b32 v219, 0xffff0000, v141
  v_pk_mul_f32 v[158:159], v[158:159], v[212:213]
  v_pk_mul_f32 v[160:161], v[160:161], v[214:215]
  v_pk_mul_f32 v[162:163], v[162:163], v[216:217]
  v_pk_mul_f32 v[164:165], v[164:165], v[218:219]
  v_cvt_pk_bf16_f32 v176, v158, v159
  v_cvt_pk_bf16_f32 v177, v160, v161
  v_cvt_pk_bf16_f32 v178, v162, v163
  v_cvt_pk_bf16_f32 v179, v164, v165
  buffer_store_dwordx4 v[176:179], v53, s[20:23], s55 offen sc1
  s_branch j_4
st_3:
  ds_read_b128 v[116:119], v98 offset:0
  ds_read_b128 v[120:123], v208 offset:0
  ds_read_b128 v[124:127], v98 offset:256
  ds_read_b128 v[128:131], v208 offset:256
  ds_read_b128 v[132:135], v98 offset:512
  ds_read_b128 v[136:139], v208 offset:512
  s_waitcnt lgkmcnt(8)
  v_alignbit_b32 v72, v72, v72, 16
  v_alignbit_b32 v73, v73, v73, 16
  v_alignbit_b32 v150, v101, v100, 16
  v_alignbit_b32 v151, v102, v101, 16
  v_alignbit_b32 v152, v103, v102, 16
  v_alignbit_b32 v153, v104, v103, 16
  v_alignbit_b32 v154, v105, v104, 16
  v_dot2_f32_bf16 v159, v101, v73, 0
  v_dot2_f32_bf16 v158, v150, v73, 0
  v_dot2_f32_bf16 v161, v102, v73, 0
  v_dot2_f32_bf16 v160, v151, v73, 0
  v_dot2_f32_bf16 v163, v103, v73, 0
  v_dot2_f32_bf16 v162, v152, v73, 0
  v_dot2_f32_bf16 v165, v104, v73, 0
  v_dot2_f32_bf16 v164, v153, v73, 0
  v_dot2_f32_bf16 v159, v102, v72, v159
  v_dot2_f32_bf16 v158, v151, v72, v158
  v_dot2_f32_bf16 v161, v103, v72, v161
  v_dot2_f32_bf16 v160, v152, v72, v160
  v_dot2_f32_bf16 v163, v104, v72, v163
  v_dot2_f32_bf16 v162, v153, v72, v162
  v_dot2_f32_bf16 v165, v105, v72, v165
  v_dot2_f32_bf16 v164, v154, v72, v164
  s_waitcnt lgkmcnt(6)
  buffer_store_dwordx4 v[112:115], v53, s[20:23], s63 offen sc1
  v_lshlrev_b32 v212, 16, v106
  v_and_b32 v213, 0xffff0000, v106
  v_lshlrev_b32 v214, 16, v107
  v_and_b32 v215, 0xffff0000, v107
  v_lshlrev_b32 v216, 16, v108
  v_and_b32 v217, 0xffff0000, v108
  v_lshlrev_b32 v218, 16, v109
  v_and_b32 v219, 0xffff0000, v109
  v_pk_mul_f32 v[158:159], v[158:159], v[212:213]
  v_pk_mul_f32 v[160:161], v[160:161], v[214:215]
  v_pk_mul_f32 v[162:163], v[162:163], v[216:217]
  v_pk_mul_f32 v[164:165], v[164:165], v[218:219]
  v_cvt_pk_bf16_f32 v168, v158, v159
  v_cvt_pk_bf16_f32 v169, v160, v161
  v_cvt_pk_bf16_f32 v170, v162, v163
  v_cvt_pk_bf16_f32 v171, v164, v165
  buffer_store_dwordx4 v[168:171], v53, s[20:23], s55 offen sc1
  s_add_u32 s55, s55, 4096
  s_add_u32 s63, s63, 4096
  ds_read_b128 v[140:143], v98 offset:768
  ds_read_b128 v[144:147], v208 offset:768
  ds_read_b128 v[220:223], v98 offset:1024
  ds_read_b128 v[224:227], v208 offset:1024
  s_mov_b32 s61, 0x3f803f80
  s_waitcnt lgkmcnt(9)
  v_dot2_f32_bf16 v200, v116, s61, 0
  v_dot2_f32_bf16 v201, v116, v116, 0
  v_dot2_f32_bf16 v200, v117, s61, v200
  v_dot2_f32_bf16 v201, v117, v117, v201
  v_dot2_f32_bf16 v200, v118, s61, v200
  v_dot2_f32_bf16 v201, v118, v118, v201
  v_dot2_f32_bf16 v200, v119, s61, v200
  v_dot2_f32_bf16 v201, v119, v119, v201
  s_waitcnt lgkmcnt(8)
  v_dot2_f32_bf16 v200, v120, s61, v200
  v_dot2_f32_bf16 v201, v120, v120, v201
  v_dot2_f32_bf16 v200, v121, s61, v200
  v_dot2_f32_bf16 v201, v121, v121, v201
  v_dot2_f32_bf16 v200, v122, s61, v200
  v_dot2_f32_bf16 v201, v122, v122, v201
  v_dot2_f32_bf16 v200, v123, s61, v200
  v_dot2_f32_bf16 v201, v123, v123, v201
  s_waitcnt lgkmcnt(7)
  v_dot2_f32_bf16 v200, v124, s61, v200
  v_dot2_f32_bf16 v201, v124, v124, v201
  v_dot2_f32_bf16 v200, v125, s61, v200
  v_dot2_f32_bf16 v201, v125, v125, v201
  v_dot2_f32_bf16 v200, v126, s61, v200
  v_dot2_f32_bf16 v201, v126, v126, v201
  v_dot2_f32_bf16 v200, v127, s61, v200
  v_dot2_f32_bf16 v201, v127, v127, v201
  s_waitcnt lgkmcnt(6)
  v_dot2_f32_bf16 v200, v128, s61, v200
  v_dot2_f32_bf16 v201, v128, v128, v201
  v_dot2_f32_bf16 v200, v129, s61, v200
  v_dot2_f32_bf16 v201, v129, v129, v201
  v_dot2_f32_bf16 v200, v130, s61, v200
  v_dot2_f32_bf16 v201, v130, v130, v201
  v_dot2_f32_bf16 v200, v131, s61, v200
  v_dot2_f32_bf16 v201, v131, v131, v201
  s_waitcnt lgkmcnt(5)
  v_dot2_f32_bf16 v200, v132, s61, v200
  v_dot2_f32_bf16 v201, v132, v132, v201
  v_dot2_f32_bf16 v200, v133, s61, v200
  v_dot2_f32_bf16 v201, v133, v133, v201
  v_dot2_f32_bf16 v200, v134, s61, v200
  v_dot2_f32_bf16 v201, v134, v134, v201
  v_dot2_f32_bf16 v200, v135, s61, v200
  v_dot2_f32_bf16 v201, v135, v135, v201
  s_waitcnt lgkmcnt(4)
  v_dot2_f32_bf16 v200, v136, s61, v200
  v_dot2_f32_bf16 v201, v136, v136, v201
  v_dot2_f32_bf16 v200, v137, s61, v200
  v_dot2_f32_bf16 v201, v137, v137, v201
  v_dot2_f32_bf16 v200, v138, s61, v200
  v_dot2_f32_bf16 v201, v138, v138, v201
  v_dot2_f32_bf16 v200, v139, s61, v200
  v_dot2_f32_bf16 v201, v139, v139, v201
  s_waitcnt lgkmcnt(3)
  v_dot2_f32_bf16 v200, v140, s61, v200
  v_dot2_f32_bf16 v201, v140, v140, v201
  v_dot2_f32_bf16 v200, v141, s61, v200
  v_dot2_f32_bf16 v201, v141, v141, v201
  v_dot2_f32_bf16 v200, v142, s61, v200
  v_dot2_f32_bf16 v201, v142, v142, v201
  v_dot2_f32_bf16 v200, v143, s61, v200
  v_dot2_f32_bf16 v201, v143, v143, v201
  s_waitcnt lgkmcnt(2)
  v_dot2_f32_bf16 v200, v144, s61, v200
  v_dot2_f32_bf16 v201, v144, v144, v201
  v_dot2_f32_bf16 v200, v145, s61, v200
  v_dot2_f32_bf16 v201, v145, v145, v201
  v_dot2_f32_bf16 v200, v146, s61, v200
  v_dot2_f32_bf16 v201, v146, v146, v201
  v_dot2_f32_bf16 v200, v147, s61, v200
  v_dot2_f32_bf16 v201, v147, v147, v201
  s_waitcnt lgkmcnt(1)
  v_dot2_f32_bf16 v200, v220, s61, v200
  v_dot2_f32_bf16 v201, v220, v220, v201
  v_dot2_f32_bf16 v200, v221, s61, v200
  v_dot2_f32_bf16 v201, v221, v221, v201
  v_dot2_f32_bf16 v200, v222, s61, v200
  v_dot2_f32_bf16 v201, v222, v222, v201
  v_dot2_f32_bf16 v200, v223, s61, v200
  v_dot2_f32_bf16 v201, v223, v223, v201
  s_waitcnt lgkmcnt(0)
  v_dot2_f32_bf16 v200, v224, s61, v200
  v_dot2_f32_bf16 v201, v224, v224, v201
  v_dot2_f32_bf16 v200, v225, s61, v200
  v_dot2_f32_bf16 v201, v225, v225, v201
  v_dot2_f32_bf16 v200, v226, s61, v200
  v_dot2_f32_bf16 v201, v226, v226, v201
  v_dot2_f32_bf16 v200, v227, s61, v200
  v_dot2_f32_bf16 v201, v227, v227, v201
  s_nop 1
  v_add_f32_dpp v200, v200, v200 quad_perm:[1,0,3,2] row_mask:0xf bank_mask:0xf
  v_add_f32_dpp v201, v201, v201 quad_perm:[1,0,3,2] row_mask:0xf bank_mask:0xf
  s_nop 0
  v_add_f32_dpp v200, v200, v200 quad_perm:[2,3,0,1] row_mask:0xf bank_mask:0xf
  v_add_f32_dpp v201, v201, v201 quad_perm:[2,3,0,1] row_mask:0xf bank_mask:0xf
  s_nop 0
  v_add_f32_dpp v200, v200, v200 row_half_mirror row_mask:0xf bank_mask:0xf
  v_add_f32_dpp v201, v201, v201 row_half_mirror row_mask:0xf bank_mask:0xf
  v_mul_f32 v200, 0.0015625, v200
  v_mul_f32 v201, 0.0015625, v201
  v_fma_f32 v201, -v200, v200, v201
  v_max_f32 v201, 0, v201
  v_add_f32 v201, 1e-05, v201
  v_rsq_f32 v201, v201
  v_and_b32 v2, 7, v1
  v_cmp_eq_u32 vcc, 0, v2
  v_mul_f32_e64 v200, -v200, v201
  s_nop 0
  v_cndmask_b32 v200, v200, v201, vcc
  buffer_store_dword v200, v99, s[20:23], s62 offen sc1
j_4:
  global_load_dword v8, v204, s[4:5] sc1
  s_and_b32 s58, s51, 1
  s_lshl_b32 s58, s58, 4
  s_lshr_b64 s[70:71], s[70:71], s58
  s_lshl_b32 s72, s71, 16
  s_and_b32 s71, s70, 0xffff0000
  s_lshl_b32 s70, s70, 16
  v_lshrrev_b32 v2, 4, v1
  v_and_b32 v3, 15, v1
  v_lshlrev_b32 v56, 1, v2
  v_xor_b32 v56, v56, v3
  v_lshlrev_b32 v56, 4, v56
  v_mul_u32_u24 v57, 3072, v2
  v_add_u32 v240, v56, v57
  v_xor_b32 v241, 128, v240
  v_add_u32 v241, 11264, v241
  s_and_b32 s56, s3, 1
  s_lshl_b32 s56, s56, 7
  v_xor_b32 v56, s56, v56
  v_mul_u32_u24 v57, 1280, v2
  v_add_u32 v242, v56, v57
  v_add_u32 v243, 4096, v242
  s_mul_i32 s56, s2, 171
  s_lshr_b32 s57, s56, 9
  s_lshr_b32 s56, s56, 11
  s_mul_i32 s58, s57, 3
  s_sub_u32 s58, s2, s58
  s_and_b32 s57, s57, 3
  s_lshl_b32 s59, s56, 2
  s_add_u32 s59, s59, s3
  s_mul_i32 s59, s59, 24576
  s_mul_i32 s60, s57, 768
  s_add_u32 s59, s59, s60
  s_lshl_b32 s60, s58, 8
  s_add_u32 s59, s59, s60
  s_cmp_lt_u32 s2, 240
  s_cselect_b32 s0, s59, 2146435072
  s_mul_i32 s56, s2, 205
  s_lshr_b32 s56, s56, 10
  s_mul_i32 s57, s56, 5
  s_sub_u32 s57, s2, s57
  s_lshl_b32 s59, s56, 2
  s_add_u32 s59, s59, s3
  s_mul_i32 s59, s59, 10240
  s_lshl_b32 s60, s57, 8
  s_add_u32 s59, s59, s60
  s_cmp_lt_u32 s2, 240
  s_cselect_b32 s1, s59, 2146435072
  s_and_b32 s56, s49, 15
  s_lshl_b32 s56, s56, 10
  v_lshlrev_b32 v56, 14, v0
  v_add_u32 v56, s56, v56
  v_mov_b32 v57, 0x7ffff000
  v_cmp_gt_u32 vcc, 8, v0
  s_nop 1
  v_cndmask_b32 v5, v57, v56, vcc
  v_and_b32 v60, 15, v1
  v_lshrrev_b32 v61, 4, v1
  v_and_b32 v62, 1, v61
  v_and_b32 v6, 3, v1
  v_lshlrev_b32 v6, 10, v6
  s_lshl2_add_u32 s56, s48, s3
  s_lshl_b32 s56, s56, 12
  v_add_u32 v6, s56, v6
  v_add_u32 v56, 0, v1
  v_mul_u32_u24 v57, 21846, v56
  v_lshrrev_b32 v57, 16, v57
  v_mul_u32_u24 v57, 10320, v57
  v_lshl_add_u32 v9, v56, 4, v57
  v_add_u32 v56, 64, v1
  v_mul_u32_u24 v57, 21846, v56
  v_lshrrev_b32 v57, 16, v57
  v_mul_u32_u24 v57, 10320, v57
  v_lshl_add_u32 v10, v56, 4, v57
  v_add_u32 v56, 128, v1
  v_mul_u32_u24 v57, 21846, v56
  v_lshrrev_b32 v57, 16, v57
  v_mul_u32_u24 v57, 10320, v57
  v_lshl_add_u32 v11, v56, 4, v57
  s_mul_i32 s56, s3, 663552
  s_lshl_b32 s57, s51, 4
  s_add_u32 s56, s56, s57
  s_add_u32 s9, s56, 4194304
  s_add_u32 s8, s56, 1048576
  s_mul_i32 s10, s3, 3072
  s_lshl_b32 s11, s3, 12
  s_add_u32 s11, s11, 75968
  s_lshl_b32 s12, s3, 12
  s_add_u32 s12, s12, 262144
  v_lshl_add_u32 v58, v60, 1, v61
  v_mul_u32_u24 v58, 48, v58
  v_sub_u32 v59, 15, v60
  v_lshl_add_u32 v59, v61, 3, v59
  v_and_b32 v56, 3, v59
  v_mul_u32_u24 v56, 4160, v56
  v_and_b32 v59, 0xfc, v59
  v_lshl_add_u32 v59, v59, 1, v56
  s_lshr_b32 s60, s3, 1
  s_add_u32 s60, s60, s52
  s_lshl_b32 s61, s52, 1
  s_sub_u32 s61, 2, s61
  s_and_b32 s56, s3, 1
  s_lshl_b32 s56, s56, 2
  s_sub_u32 s56, 4, s56
  s_mul_i32 s57, s60, 16640
  s_lshl_b32 s58, s56, 6
  s_add_u32 s57, s57, s58
  v_add_u32 v12, s57, v59
  s_lshl_b32 s57, s60, 4
  s_mul_i32 s58, s56, 192
  s_add_u32 s57, s57, s58
  s_add_u32 s57, s57, 49920
  v_add_u32 v13, s57, v58
  s_lshl_b32 s56, s3, 1
  s_sub_u32 s56, 6, s56
  s_mul_i32 s57, s61, 16640
  s_lshl_b32 s58, s56, 6
  s_add_u32 s57, s57, s58
  v_add_u32 v14, s57, v59
  s_lshl_b32 s57, s61, 4
  s_mul_i32 s58, s56, 192
  s_add_u32 s57, s57, s58
  s_add_u32 s57, s57, 49920
  v_add_u32 v15, s57, v58
  v_lshlrev_b32 v56, 5, v62
  v_lshl_add_u32 v56, v60, 1, v56
  v_lshrrev_b32 v57, 1, v61
  v_add_u32 v56, v56, v57
  s_and_b32 s56, s3, 1
  s_lshl_b32 s56, s56, 6
  v_add_u32 v56, s56, v56
  s_lshl_b32 s56, s60, 4
  s_add_u32 s56, s56, 63648
  v_mul_u32_u24 v57, 48, v56
  v_add_u32 v16, s56, v57
  v_xor_b32 v57, v56, v62
  v_lshlrev_b32 v57, 6, v57
  v_bfe_u32 v17, v56, 2, 2
  v_lshl_add_u32 v57, v17, 4, v57
  v_add_u32 v17, 75968, v57
  s_add_u32 s56, s51, s60
  s_lshr_b32 s57, s56, 1
  s_and_b32 s57, s57, 2
  s_lshl_b32 s13, s56, 6
  s_add_u32 s13, s13, 14680064
  v_lshrrev_b32 v57, 2, v56
  v_mul_u32_u24 v57, 41088, v57
  v_and_b32 v56, 3, v56
  v_xor_b32 v56, s57, v56
  v_lshl_add_u32 v18, v56, 4, v57
  v_and_b32 v56, 127, v0
  v_lshrrev_b32 v57, 3, v56
  v_bfe_u32 v58, v56, 1, 2
  v_lshl_add_u32 v57, v58, 2, v57
  v_and_b32 v57, 15, v57
  v_lshl_add_u32 v57, v58, 4, v57
  v_lshlrev_b32 v57, 4, v57
  v_and_b32 v58, 1, v56
  v_lshl_add_u32 v57, v58, 3, v57
  s_lshr_b32 s56, s3, 1
  s_lshl_b32 s57, s56, 10
  s_add_u32 s57, s57, 108800
  v_add_u32 v19, s57, v57
  s_mul_i32 s57, s56, 3
  s_add_u32 s56, s56, 1
  s_cmp_eq_u32 s52, 0
  s_cselect_b32 s56, s57, s56
  s_and_b32 s58, s56, 1
  s_lshl_b32 s56, s56, 5
  v_lshrrev_b32 v57, 2, v56
  v_add_u32 v57, s56, v57
  v_and_b32 v59, 3, v56
  s_lshl_b32 s56, s61, 4
  s_add_u32 s56, s56, 63648
  v_mul_u32_u24 v20, 48, v57
  v_lshl_add_u32 v20, v59, 2, v20
  v_add_u32 v20, s56, v20
  v_xor_b32 v21, s58, v57
  v_lshlrev_b32 v21, 6, v21
  v_lshl_add_u32 v21, v58, 3, v21
  v_bfe_u32 v56, v56, 1, 1
  v_bfe_u32 v58, v57, 2, 2
  v_xor_b32 v56, v56, v58
  v_lshl_add_u32 v21, v56, 4, v21
  v_add_u32 v21, 75968, v21
  s_add_u32 s56, s51, s61
  s_lshr_b32 s57, s56, 1
  s_and_b32 s57, s57, 2
  s_lshl_b32 s14, s56, 6
  s_add_u32 s14, s14, 14680064
  v_lshrrev_b32 v56, 2, v57
  v_mul_u32_u24 v56, 41088, v56
  v_lshl_add_u32 v56, v59, 2, v56
  v_and_b32 v57, 3, v57
  v_xor_b32 v57, s57, v57
  v_lshl_add_u32 v22, v57, 4, v56
  s_lshl_b32 s56, s3, 11
  s_add_u32 s57, s56, 92416
  v_add_u32 v23, s57, v4
  v_lshl_add_u32 v56, v61, 2, v60
  v_and_b32 v56, 15, v56
  v_lshl_add_u32 v56, v61, 4, v56
  v_lshlrev_b32 v56, 4, v56
  v_add_u32 v25, s57, v56
  s_xor_b32 s56, s56, 2048
  s_add_u32 s57, s56, 92416
  v_add_u32 v24, s57, v4
  s_lshl_b32 s56, s3, 12
  s_add_u32 s56, s56, 92416
  v_add_u32 v253, s56, v4
  s_lshr_b32 s56, s3, 1
  s_lshl_b32 s56, s56, 13
  s_and_b32 s57, s3, 1
  s_lshl_b32 s57, s57, 11
  s_add_u32 s56, s56, s57
  s_add_u32 s56, s56, 92416
  v_lshlrev_b32 v56, 10, v62
  v_lshrrev_b32 v57, 1, v61
  v_lshl_add_u32 v56, v57, 9, v56
  v_lshl_add_u32 v56, v60, 4, v56
  v_add_u32 v250, s56, v56
  v_lshlrev_b32 v56, 6, v60
  v_lshl_add_u32 v251, v61, 4, v56
  v_mov_b32 v57, 0x7ffff000
  v_cmp_gt_u32 vcc, 4, v60
  s_nop 1
  v_cndmask_b32 v252, v57, v251, vcc
  v_cmp_eq_u32 vcc, 0, v60
  s_nop 1
  v_cndmask_b32 v254, v57, v251, vcc
  s_waitcnt vmcnt(0)
  v_cmp_gt_u32 vcc, 8, v8
  s_cbranch_vccnz slow_5
back_6:
  s_barrier
  buffer_atomic_add v7, v5, s[20:23], 0 offen offset:0 sc1
  s_lshl_b32 s56, s3, 11
  s_add_u32 m0, s56, 133376
  s_nop 0
  buffer_load_dwordx4 v240, s[32:35], s0 offen offset:0  lds
  buffer_load_dwordx4 v241, s[32:35], s0 offen offset:1024  lds
  s_add_u32 m0, s56, 141568
  s_nop 0
  buffer_load_dwordx4 v240, s[36:39], s0 offen offset:0  lds
  buffer_load_dwordx4 v241, s[36:39], s0 offen offset:1024  lds
  s_lshl_b32 s56, s3, 11
  s_add_u32 m0, s56, 149760
  s_nop 0
  buffer_load_dwordx4 v242, s[40:43], s1 offen offset:0  lds
  buffer_load_dwordx4 v243, s[40:43], s1 offen offset:1024  lds
  s_mov_b32 s60, 0xffff
  v_sub_u32 v2, 4080, v53
  v_lshlrev_b32 v3, 16, v80
  v_add_f32 v3, s70, v3
  v_cvt_pk_bf16_f32 v3, v3, v3
  v_bfi_b32 v3, s60, v3, v80
  v_cndmask_b32 v80, v80, v3, s[66:67]
  v_alignbit_b32 v128, v83, v83, 16
  v_alignbit_b32 v129, v82, v82, 16
  v_alignbit_b32 v130, v81, v81, 16
  v_alignbit_b32 v131, v80, v80, 16
  ds_write_b128 v2, v[128:131] offset:0
  v_bfi_b32 v132, s60, v83, v82
  v_bfi_b32 v133, s60, v82, v81
  v_bfi_b32 v134, s60, v81, v80
  v_bfi_b32 v135, s60, v80, v79
  ds_write_b128 v2, v[132:135] offset:4160
  v_alignbit_b32 v136, v82, v82, 16
  v_alignbit_b32 v137, v81, v81, 16
  v_alignbit_b32 v138, v80, v80, 16
  v_alignbit_b32 v139, v79, v79, 16
  ds_write_b128 v2, v[136:139] offset:8320
  v_bfi_b32 v140, s60, v82, v81
  v_bfi_b32 v141, s60, v81, v80
  v_bfi_b32 v142, s60, v80, v79
  v_bfi_b32 v143, s60, v79, v78
  ds_write_b128 v2, v[140:143] offset:12480
  v_lshlrev_b32 v3, 16, v86
  v_add_f32 v3, s71, v3
  v_cvt_pk_bf16_f32 v3, v3, v3
  v_bfi_b32 v3, s60, v3, v86
  v_cndmask_b32 v86, v86, v3, s[66:67]
  v_alignbit_b32 v144, v89, v89, 16
  v_alignbit_b32 v145, v88, v88, 16
  v_alignbit_b32 v146, v87, v87, 16
  v_alignbit_b32 v147, v86, v86, 16
  ds_write_b128 v2, v[144:147] offset:16640
  v_bfi_b32 v148, s60, v89, v88
  v_bfi_b32 v149, s60, v88, v87
  v_bfi_b32 v150, s60, v87, v86
  v_bfi_b32 v151, s60, v86, v85
  ds_write_b128 v2, v[148:151] offset:20800
  v_alignbit_b32 v152, v88, v88, 16
  v_alignbit_b32 v153, v87, v87, 16
  v_alignbit_b32 v154, v86, v86, 16
  v_alignbit_b32 v155, v85, v85, 16
  ds_write_b128 v2, v[152:155] offset:24960
  v_bfi_b32 v156, s60, v88, v87
  v_bfi_b32 v157, s60, v87, v86
  v_bfi_b32 v158, s60, v86, v85
  v_bfi_b32 v159, s60, v85, v84
  ds_write_b128 v2, v[156:159] offset:29120
  v_lshlrev_b32 v3, 16, v92
  v_add_f32 v3, s72, v3
  v_cvt_pk_bf16_f32 v3, v3, v3
  v_bfi_b32 v3, s60, v3, v92
  v_cndmask_b32 v92, v92, v3, s[66:67]
  v_alignbit_b32 v160, v95, v95, 16
  v_alignbit_b32 v161, v94, v94, 16
  v_alignbit_b32 v162, v93, v93, 16
  v_alignbit_b32 v163, v92, v92, 16
  ds_write_b128 v2, v[160:163] offset:33280
  v_bfi_b32 v164, s60, v95, v94
  v_bfi_b32 v165, s60, v94, v93
  v_bfi_b32 v166, s60, v93, v92
  v_bfi_b32 v167, s60, v92, v91
  ds_write_b128 v2, v[164:167] offset:37440
  v_alignbit_b32 v168, v94, v94, 16
  v_alignbit_b32 v169, v93, v93, 16
  v_alignbit_b32 v170, v92, v92, 16
  v_alignbit_b32 v171, v91, v91, 16
  ds_write_b128 v2, v[168:171] offset:41600
  v_bfi_b32 v172, s60, v94, v93
  v_bfi_b32 v173, s60, v93, v92
  v_bfi_b32 v174, s60, v92, v91
  v_bfi_b32 v175, s60, v91, v90
  ds_write_b128 v2, v[172:175] offset:45760
  v_lshrrev_b32 v2, 4, v1
  s_mul_i32 s56, s2, 171
  s_lshr_b32 s57, s56, 9
  s_lshr_b32 s56, s56, 11
  s_mul_i32 s58, s57, 3
  s_sub_u32 s58, s2, s58
  s_and_b32 s57, s57, 3
  s_cmp_lt_u32 s2, 240
  s_cselect_b32 s62, 0, 2146435072
  s_add_u32 s62, s62, 8388608
  s_lshl_b32 s36, s56, 6
  s_mul_i32 s59, s57, 61440
  s_add_u32 s36, s36, s59
  s_add_u32 s36, s36, s62
  s_sub_u32 s36, s36, 1048576
  s_mul_i32 s59, s56, 52
  s_lshr_b32 s59, s59, 8
  s_mul_i32 s60, s59, 5
  s_sub_u32 s56, s56, s60
  s_mul_i32 s60, s57, 320
  s_add_u32 s56, s56, s60
  v_bfe_u32 v56, v1, 2, 3
  v_lshlrev_b32 v56, 5, v56
  v_lshrrev_b32 v57, 2, v1
  v_lshlrev_b32 v57, 8, v57
  v_add_u32 v57, 133376, v57
  v_and_b32 v58, 1, v1
  v_bfe_u32 v59, v1, 1, 1
  s_lshl_b32 s57, s3, 6
  v_xor_b32 v56, s57, v56
  s_cmp_eq_u32 s58, 2
  s_cbranch_scc1 mx_7
  v_lshl_add_u32 v56, v59, 4, v56
  v_lshl_add_u32 v56, v58, 3, v56
  v_add_u32 v244, v56, v57
  v_xor_b32 v246, 32, v244
  v_add_u32 v245, 8192, v244
  v_add_u32 v247, 8192, v246
  s_lshl_b32 s61, s58, 2
  s_add_u32 s61, s61, s3
  s_lshl_b32 s61, s61, 1
  s_sub_u32 s60, s59, s61
  s_and_b32 s60, s60, 3
  s_lshl2_add_u32 s60, s61, s60
  s_mul_i32 s60, s60, 5
  s_add_u32 s60, s60, s56
  s_mul_i32 s60, s60, 3072
  s_add_u32 s60, s60, s62
  s_add_u32 s28, s60, 0
  s_mul_i32 s60, s61, 3840
  s_add_u32 s60, s60, s36
  s_add_u32 s32, s60, 0
  s_add_u32 s29, s28, 1024
  s_add_u32 s33, s32, 1280
  s_add_u32 s61, s61, 1
  s_sub_u32 s60, s59, s61
  s_and_b32 s60, s60, 3
  s_lshl2_add_u32 s60, s61, s60
  s_mul_i32 s60, s60, 5
  s_add_u32 s60, s60, s56
  s_mul_i32 s60, s60, 3072
  s_add_u32 s60, s60, s62
  s_add_u32 s30, s60, 0
  s_mul_i32 s60, s61, 3840
  s_add_u32 s60, s60, s36
  s_add_u32 s34, s60, 0
  s_add_u32 s31, s30, 1024
  s_add_u32 s35, s34, 1280
  s_branch j_8
mx_7:
  v_lshl_add_u32 v56, v59, 3, v56
  v_lshl_add_u32 v56, v58, 13, v56
  v_add_u32 v244, v56, v57
  v_xor_b32 v245, 16, v244
  v_xor_b32 v246, 32, v244
  v_xor_b32 v247, 48, v244
  s_lshl_b32 s61, s3, 2
  s_sub_u32 s60, s59, s61
  s_and_b32 s60, s60, 3
  s_lshl2_add_u32 s60, s61, s60
  s_mul_i32 s60, s60, 5
  s_add_u32 s60, s60, s56
  s_mul_i32 s60, s60, 3072
  s_add_u32 s60, s60, s62
  s_add_u32 s28, s60, 2048
  s_mul_i32 s60, s61, 3840
  s_add_u32 s60, s60, s36
  s_add_u32 s32, s60, 2560
  s_add_u32 s61, s61, 1
  s_sub_u32 s60, s59, s61
  s_and_b32 s60, s60, 3
  s_lshl2_add_u32 s60, s61, s60
  s_mul_i32 s60, s60, 5
  s_add_u32 s60, s60, s56
  s_mul_i32 s60, s60, 3072
  s_add_u32 s60, s60, s62
  s_add_u32 s29, s60, 2048
  s_mul_i32 s60, s61, 3840
  s_add_u32 s60, s60, s36
  s_add_u32 s33, s60, 2560
  s_add_u32 s61, s61, 1
  s_sub_u32 s60, s59, s61
  s_and_b32 s60, s60, 3
  s_lshl2_add_u32 s60, s61, s60
  s_mul_i32 s60, s60, 5
  s_add_u32 s60, s60, s56
  s_mul_i32 s60, s60, 3072
  s_add_u32 s60, s60, s62
  s_add_u32 s30, s60, 2048
  s_mul_i32 s60, s61, 3840
  s_add_u32 s60, s60, s36
  s_add_u32 s34, s60, 2560
  s_add_u32 s61, s61, 1
  s_sub_u32 s60, s59, s61
  s_and_b32 s60, s60, 3
  s_lshl2_add_u32 s60, s61, s60
  s_mul_i32 s60, s60, 5
  s_add_u32 s60, s60, s56
  s_mul_i32 s60, s60, 3072
  s_add_u32 s60, s60, s62
  s_add_u32 s31, s60, 2048
  s_mul_i32 s60, s61, 3840
  s_add_u32 s60, s60, s36
  s_add_u32 s35, s60, 2560
j_8:
  s_mul_i32 s56, s2, 205
  s_lshr_b32 s56, s56, 10
  s_mul_i32 s57, s56, 5
  s_sub_u32 s57, s2, s57
  s_lshl_b32 s59, s56, 2
  s_add_u32 s59, s59, s3
  s_mul_i32 s59, s59, 10240
  s_lshl_b32 s60, s57, 8
  s_add_u32 s59, s59, s60
  s_cmp_lt_u32 s2, 240
  s_cselect_b32 s1, s59, 2146435072
  s_cselect_b32 s62, 0, 2146435072
  s_add_u32 s62, s62, 12582912
  s_mul_i32 s56, s56, 5120
  s_add_u32 s62, s62, s56
  s_lshl_b32 s57, s57, 2
  s_add_u32 s57, s57, s3
  s_lshl_b32 s57, s57, 1
  s_mul_i32 s59, s57, 52
  s_lshr_b32 s59, s59, 8
  s_mul_i32 s59, s59, 240640
  s_lshl_b32 s60, s57, 10
  s_add_u32 s59, s59, s60
  s_add_u32 s6, s59, s62
  s_add_u32 s57, s57, 1
  s_mul_i32 s59, s57, 52
  s_lshr_b32 s59, s59, 8
  s_mul_i32 s59, s59, 240640
  s_lshl_b32 s60, s57, 10
  s_add_u32 s59, s59, s60
  s_add_u32 s7, s59, s62
  v_bfe_u32 v56, v1, 2, 3
  v_lshlrev_b32 v56, 5, v56
  s_lshl_b32 s57, s3, 6
  v_xor_b32 v56, s57, v56
  v_lshl_add_u32 v56, v59, 4, v56
  v_lshl_add_u32 v56, v58, 3, v56
  v_bfe_u32 v57, v1, 2, 2
  v_lshl_add_u32 v57, v2, 3, v57
  v_lshlrev_b32 v57, 8, v57
  v_add_u32 v57, 149760, v57
  v_add_u32 v248, v56, v57
  v_xor_b32 v249, 32, v248
  buffer_load_dword v8, v6, s[20:23], 0 offen offset:0 sc1
  s_waitcnt vmcnt(0)
  v_cmp_ne_u32 vcc, 16, v8
  s_cbranch_vccnz slow_9
back_10:
  s_waitcnt vmcnt(0)
  s_barrier
  s_add_u32 m0, s10, 51360
  s_nop 0
  buffer_load_dwordx4 v9, s[20:23], s8 offen sc1 lds
  s_add_u32 m0, s10, 52384
  s_nop 0
  buffer_load_dwordx4 v10, s[20:23], s8 offen sc1 lds
  s_add_u32 m0, s10, 53408
  s_nop 0
  buffer_load_dwordx4 v11, s[20:23], s8 offen sc1 lds
  ds_read_b64_tr_b16 v[208:209], v244 offset:0
  ds_read_b64_tr_b16 v[210:211], v244 offset:4096
  ds_read_b64_tr_b16 v[212:213], v245 offset:0
  ds_read_b64_tr_b16 v[214:215], v245 offset:4096
  ds_read_b64_tr_b16 v[216:217], v246 offset:0
  ds_read_b64_tr_b16 v[218:219], v246 offset:4096
  ds_read_b64_tr_b16 v[220:221], v247 offset:0
  ds_read_b64_tr_b16 v[222:223], v247 offset:4096
  s_lshl_b32 s62, s54, 2
  s_add_u32 s62, s62, s3
  s_mul_i32 s15, s62, 61440
  s_add_u32 s15, s15, 8388608
  s_mul_i32 s36, s62, 3840
  s_add_u32 s36, s36, 7340032
  v_lshrrev_b32 v56, 2, v1
  v_lshlrev_b32 v56, 6, v56
  v_and_b32 v57, 3, v1
  v_lshl_add_u32 v56, v57, 3, v56
  v_lshl_add_u32 v58, v62, 5, v56
  s_add_u32 s57, s3, 0
  s_and_b32 s57, s57, 3
  s_mul_i32 s57, s57, 10240
  v_add_u32 v26, s57, v58
  v_xor_b32 v27, 32, v26
  s_add_u32 s57, s3, 1
  s_and_b32 s57, s57, 3
  s_mul_i32 s57, s57, 10240
  v_add_u32 v28, s57, v58
  v_xor_b32 v29, 32, v28
  s_add_u32 s57, s3, 2
  s_and_b32 s57, s57, 3
  s_mul_i32 s57, s57, 10240
  v_add_u32 v30, s57, v58
  v_xor_b32 v31, 32, v30
  s_add_u32 s57, s3, 3
  s_and_b32 s57, s57, 3
  s_mul_i32 s57, s57, 10240
  v_add_u32 v32, s57, v58
  v_xor_b32 v33, 32, v32
  v_mul_u32_u24 v58, 49152, v62
  v_lshl_add_u32 v58, v60, 4, v58
  v_lshrrev_b32 v59, 1, v61
  v_lshl_add_u32 v34, v59, 8, v58
  v_lshl_add_u32 v35, v59, 3, v58
  s_and_b32 s57, s62, 15
  s_lshl_b32 s58, s57, 9
  v_add_u32 v34, s58, v34
  s_lshl_b32 s58, s57, 8
  s_add_u32 s58, s58, 8192
  v_add_u32 v35, s58, v35
  s_lshl_b32 s57, s3, 11
  s_add_u32 s57, s57, 81920
  v_add_u32 v36, s57, v4
  s_lshl_b32 s57, s3, 9
  s_add_u32 s57, s57, 90112
  v_lshlrev_b32 v37, 2, v1
  v_add_u32 v37, s57, v37
  v_lshrrev_b32 v58, 2, v60
  v_lshl_add_u32 v58, v58, 4, v60
  v_lshlrev_b32 v58, 4, v58
  v_lshl_add_u32 v58, v57, 2, v58
  v_lshl_add_u32 v58, v62, 10, v58
  v_add_u32 v38, 81920, v58
  v_lshlrev_b32 v58, 2, v60
  v_lshl_add_u32 v58, v62, 8, v58
  v_add_u32 v39, 90112, v58
  v_mov_b32 v44, 0x3f803f80
  v_mov_b32 v45, 0x3f803f80
  v_mov_b32 v46, 0x3f803f80
  v_mov_b32 v47, 0x3f803f80
  s_mul_i32 s16, s53, 82176
  s_mul_i32 s17, s3, 10240
  s_add_u32 s16, s16, s17
  s_add_u32 s16, s16, 14680064
  s_mul_i32 s18, s53, 196608
  s_lshr_b32 s57, s54, 2
  s_mul_i32 s57, s57, 12288
  s_add_u32 s18, s18, s57
  s_add_u32 s18, s18, 17825792
  s_lshl2_add_u32 s56, s53, s3
  s_lshl_b32 s56, s56, 11
  s_lshr_b32 s58, s54, 2
  s_lshl_b32 s58, s58, 7
  s_add_u32 s56, s56, s58
  s_add_u32 s56, s56, 524288
  v_bfe_u32 v41, v1, 2, 2
  v_lshlrev_b32 v41, 9, v41
  v_lshl_add_u32 v41, v57, 2, v41
  v_add_u32 v41, s56, v41
  s_and_b32 s59, s54, 7
  s_lshr_b32 s60, s54, 3
  s_lshl_b32 s61, s53, 1
  s_and_b32 s57, s3, 1
  s_add_u32 s61, s61, s57
  s_lshr_b32 s57, s3, 1
  s_lshl_b32 s57, s57, 5
  s_add_u32 s61, s61, s57
  s_mul_i32 s57, s59, 48
  s_mul_i32 s58, s3, 12
  s_add_u32 s57, s57, s58
  s_mul_i32 s19, s57, 5120
  s_add_u32 s19, s19, 12582912
  s_mul_i32 s74, s61, 41088
  s_mul_i32 s58, s59, 5120
  s_add_u32 s74, s74, s58
  s_add_u32 s74, s74, 14680064
  v_xor_b32 v58, s60, v62
  v_lshl_add_u32 v58, v58, 5, v56
  v_add_u32 v42, s17, v58
  v_mul_u32_u24 v58, 1280, v60
  v_lshl_add_u32 v48, v61, 3, v58
  v_add_u32 v48, 128, v48
  v_lshl_add_u32 v58, v62, 5, v58
  v_lshl_add_u32 v43, v59, 4, v58
  s_mul_i32 s57, s3, 5120
  s_add_u32 s57, s57, 40960
  v_add_u32 v49, s57, v4
  v_add_u32 v50, 40960, v49
  s_mul_i32 s57, s3, 20480
  s_add_u32 s57, s57, 40960
  v_add_u32 v51, s57, v4
  s_mul_i32 s75, s3, 15360
  s_add_u32 s75, s75, 92160
  v_add_u32 v52, s75, v4
  s_lshl_b32 s69, s61, 1
  s_add_u32 s69, s69, s60
  s_mul_i32 s69, s69, 20480
  s_mul_i32 s57, s59, 160
  s_add_u32 s69, s69, s57
  s_lshl_b32 s68, s53, 2
  s_add_u32 s68, s68, s60
  s_mul_i32 s68, s68, 49152
  s_mul_i32 s57, s3, 12288
  s_add_u32 s68, s68, s57
  s_add_u32 s68, s68, 17825792
  s_waitcnt lgkmcnt(0)
  v_mfma_f32_16x16x32_bf16 v[224:227], v[208:211], v[44:47], 0
  v_mfma_f32_16x16x32_bf16 v[228:231], v[212:215], v[44:47], 0
  v_mfma_f32_16x16x32_bf16 v[232:235], v[216:219], v[44:47], 0
  v_mfma_f32_16x16x32_bf16 v[236:239], v[220:223], v[44:47], 0
  v_xor_b32 v200, 16, v17
  v_xor_b32 v201, 32, v17
  v_xor_b32 v202, 48, v17
  v_xor_b32 v203, 32, v21
  v_add_u32 v53, s15, v4
  v_add_u32 v53, 4096, v53
  s_add_u32 m0, s10, 63648
  s_nop 0
  buffer_load_dwordx4 v9, s[20:23], s9 offen sc1 lds
  s_add_u32 m0, s10, 64672
  s_nop 0
  buffer_load_dwordx4 v10, s[20:23], s9 offen sc1 lds
  s_add_u32 m0, s10, 65696
  s_nop 0
  buffer_load_dwordx4 v11, s[20:23], s9 offen sc1 lds
  s_waitcnt vmcnt(3)
  s_barrier
  s_cmp_lg_u32 s52, 0
  s_cbranch_scc1 e_11
  ds_read_b64 v[80:81], v14 offset:3648
  ds_read_b64 v[82:83], v14 offset:3656
  ds_read_b128 v[84:87], v15 offset:4800
  ds_read_b128 v[88:91], v15 offset:192
  ds_read_b64 v[92:93], v14 offset:3136
  ds_read_b64 v[94:95], v14 offset:3144
  ds_read_b128 v[96:99], v15 offset:3264
  ds_read_b64 v[100:101], v14 offset:2624
  ds_read_b64 v[102:103], v14 offset:2632
  ds_read_b128 v[104:107], v15 offset:1728
  ds_read_b64 v[108:109], v14 offset:2112
  ds_read_b64 v[110:111], v14 offset:2120
  ds_read_b64 v[112:113], v14 offset:3584
  ds_read_b64 v[114:115], v14 offset:3592
  ds_read_b128 v[116:119], v15 offset:4608
  s_waitcnt lgkmcnt(12)
  v_mfma_f32_16x16x32_bf16 v[76:79], v[80:83], v[84:87], 0
  s_waitcnt lgkmcnt(11)
  ds_read_b128 v[120:123], v15 offset:0
  ds_read_b64 v[124:125], v14 offset:3072
  v_mfma_f32_16x16x32_bf16 v[72:75], v[80:83], v[88:91], 0
  s_waitcnt lgkmcnt(10)
  ds_read_b64 v[126:127], v14 offset:3080
  ds_read_b128 v[128:131], v15 offset:3072
  v_mfma_f32_16x16x32_bf16 v[76:79], v[92:95], v[96:99], v[76:79]
  s_waitcnt lgkmcnt(9)
  ds_read_b64 v[132:133], v14 offset:2560
  ds_read_b64 v[134:135], v14 offset:2568
  ds_read_b128 v[136:139], v15 offset:1536
  v_mfma_f32_16x16x32_bf16 v[76:79], v[100:103], v[104:107], v[76:79]
  s_waitcnt lgkmcnt(10)
  ds_read_b64 v[140:141], v14 offset:2048
  ds_read_b64 v[142:143], v14 offset:2056
  v_mfma_f32_16x16x32_bf16 v[76:79], v[108:111], v[88:91], v[76:79]
  s_waitcnt lgkmcnt(9)
  s_mov_b32 m0, s11
  s_nop 0
  buffer_load_dwordx4 v4, s[20:23], s12 offen offset:0 sc1 lds
  ds_read_b64 v[84:85], v12 offset:3776
  ds_read_b64 v[86:87], v12 offset:3784
  ds_read_b128 v[80:83], v13 offset:5184
  v_mfma_f32_16x16x32_bf16 v[76:79], v[112:115], v[116:119], v[76:79]
  s_waitcnt lgkmcnt(11)
  ds_read_b128 v[92:95], v13 offset:3648
  ds_read_b128 v[96:99], v13 offset:2112
  v_mfma_f32_16x16x32_bf16 v[72:75], v[112:115], v[120:123], v[72:75]
  s_waitcnt lgkmcnt(10)
  buffer_load_dwordx4 v4, s[20:23], s12 offen offset:1024 sc1 lds
  v_mfma_f32_16x16x32_bf16 v[76:79], v[124:127], v[128:131], v[76:79]
  s_waitcnt lgkmcnt(7)
  ds_read_b128 v[100:103], v13 offset:576
  ds_read_b64 v[104:105], v12 offset:3264
  v_mfma_f32_16x16x32_bf16 v[76:79], v[132:135], v[136:139], v[76:79]
  s_waitcnt lgkmcnt(7)
  ds_read_b64 v[106:107], v12 offset:3272
  ds_read_b64 v[88:89], v12 offset:2752
  v_mfma_f32_16x16x32_bf16 v[76:79], v[140:143], v[120:123], v[76:79]
  s_waitcnt lgkmcnt(6)
  buffer_load_dwordx4 v4, s[20:23], s12 offen offset:2048 sc1 lds
  v_mfma_f32_16x16x32_bf16 v[68:71], v[84:87], v[80:83], 0
  s_waitcnt lgkmcnt(5)
  ds_read_b64 v[90:91], v12 offset:2760
  ds_read_b64 v[108:109], v12 offset:2240
  v_mfma_f32_16x16x32_bf16 v[64:67], v[84:87], v[92:95], 0
  s_waitcnt lgkmcnt(6)
  buffer_load_dwordx4 v4, s[20:23], s12 offen offset:3072 sc1 lds
  v_mfma_f32_16x16x32_bf16 v[60:63], v[84:87], v[96:99], 0
  s_waitcnt lgkmcnt(5)
  ds_read_b64 v[110:111], v12 offset:2248
  ds_read_b64 v[116:117], v12 offset:3712
  v_mfma_f32_16x16x32_bf16 v[56:59], v[84:87], v[100:103], 0
  s_waitcnt lgkmcnt(5)
  ds_read_b64 v[118:119], v12 offset:3720
  ds_read_b128 v[112:115], v13 offset:4992
  v_mfma_f32_16x16x32_bf16 v[68:71], v[104:107], v[92:95], v[68:71]
  ds_read_b128 v[124:127], v13 offset:3456
  ds_read_b128 v[128:131], v13 offset:1920
  v_mfma_f32_16x16x32_bf16 v[64:67], v[104:107], v[96:99], v[64:67]
  ds_read_b128 v[132:135], v13 offset:384
  ds_read_b64 v[136:137], v12 offset:3200
  v_mfma_f32_16x16x32_bf16 v[60:63], v[104:107], v[100:103], v[60:63]
  s_waitcnt lgkmcnt(9)
  ds_read_b64 v[138:139], v12 offset:3208
  ds_read_b64 v[120:121], v12 offset:2688
  v_mfma_f32_16x16x32_bf16 v[68:71], v[88:91], v[96:99], v[68:71]
  ds_read_b64 v[122:123], v12 offset:2696
  ds_read_b64 v[140:141], v12 offset:2176
  v_mfma_f32_16x16x32_bf16 v[64:67], v[88:91], v[100:103], v[64:67]
  s_waitcnt lgkmcnt(11)
  ds_read_b64 v[142:143], v12 offset:2184
  ds_read_b64 v[80:81], v12 offset:3648
  v_mfma_f32_16x16x32_bf16 v[68:71], v[108:111], v[100:103], v[68:71]
  s_waitcnt lgkmcnt(10)
  ds_read_b64 v[82:83], v12 offset:3656
  ds_read_b128 v[84:87], v13 offset:4800
  v_mfma_f32_16x16x32_bf16 v[68:71], v[116:119], v[112:115], v[68:71]
  s_waitcnt lgkmcnt(11)
  ds_read_b128 v[92:95], v13 offset:3264
  ds_read_b128 v[104:107], v13 offset:1728
  v_mfma_f32_16x16x32_bf16 v[64:67], v[116:119], v[124:127], v[64:67]
  s_waitcnt lgkmcnt(12)
  ds_read_b128 v[96:99], v13 offset:192
  ds_read_b64 v[88:89], v12 offset:3136
  v_mfma_f32_16x16x32_bf16 v[60:63], v[116:119], v[128:131], v[60:63]
  s_waitcnt lgkmcnt(13)
  ds_read_b64 v[90:91], v12 offset:3144
  v_mfma_f32_16x16x32_bf16 v[56:59], v[116:119], v[132:135], v[56:59]
  s_waitcnt lgkmcnt(12)
  ds_read_b64 v[100:101], v12 offset:2624
  ds_read_b64 v[102:103], v12 offset:2632
  v_mfma_f32_16x16x32_bf16 v[68:71], v[136:139], v[124:127], v[68:71]
  buffer_store_dwordx4 v[224:227], v254, s[20:23], s32 offen sc1
  v_mfma_f32_16x16x32_bf16 v[64:67], v[136:139], v[128:131], v[64:67]
  buffer_store_dwordx4 v[228:231], v254, s[20:23], s33 offen sc1
  v_mfma_f32_16x16x32_bf16 v[60:63], v[136:139], v[132:135], v[60:63]
  s_waitcnt lgkmcnt(12)
  buffer_store_dwordx4 v[232:235], v254, s[20:23], s34 offen sc1
  v_mfma_f32_16x16x32_bf16 v[68:71], v[120:123], v[128:131], v[68:71]
  buffer_store_dwordx4 v[236:239], v254, s[20:23], s35 offen sc1
  v_mfma_f32_16x16x32_bf16 v[64:67], v[120:123], v[132:135], v[64:67]
  s_waitcnt lgkmcnt(10)
  ds_read_b64 v[108:109], v12 offset:2112
  ds_read_b64 v[110:111], v12 offset:2120
  v_mfma_f32_16x16x32_bf16 v[68:71], v[140:143], v[132:135], v[68:71]
  s_waitcnt lgkmcnt(9)
  buffer_store_dwordx4 v[208:211], v4, s[20:23], s28 offen sc1
  v_mfma_f32_16x16x32_bf16 v[68:71], v[80:83], v[84:87], v[68:71]
  s_waitcnt lgkmcnt(8)
  ds_write_b128 v25, v[72:75] offset:16384
  v_mfma_f32_16x16x32_bf16 v[64:67], v[80:83], v[92:95], v[64:67]
  s_waitcnt lgkmcnt(8)
  v_mfma_f32_16x16x32_bf16 v[60:63], v[80:83], v[104:107], v[60:63]
  s_waitcnt lgkmcnt(7)
  v_mfma_f32_16x16x32_bf16 v[56:59], v[80:83], v[96:99], v[56:59]
  s_waitcnt lgkmcnt(5)
  ds_read_b64 v[112:113], v12 offset:3584
  ds_read_b64 v[114:115], v12 offset:3592
  v_mfma_f32_16x16x32_bf16 v[68:71], v[88:91], v[92:95], v[68:71]
  ds_read_b128 v[116:119], v13 offset:4608
  ds_read_b128 v[124:127], v13 offset:3072
  v_mfma_f32_16x16x32_bf16 v[64:67], v[88:91], v[104:107], v[64:67]
  ds_write_b128 v25, v[76:79] offset:17408
  v_mfma_f32_16x16x32_bf16 v[60:63], v[88:91], v[96:99], v[60:63]
  s_waitcnt lgkmcnt(8)
  ds_read_b128 v[136:139], v13 offset:1536
  v_mfma_f32_16x16x32_bf16 v[68:71], v[100:103], v[104:107], v[68:71]
  ds_read_b128 v[128:131], v13 offset:0
  v_mfma_f32_16x16x32_bf16 v[64:67], v[100:103], v[96:99], v[64:67]
  s_waitcnt lgkmcnt(8)
  ds_read_b64 v[120:121], v12 offset:3072
  ds_read_b64 v[122:123], v12 offset:3080
  v_mfma_f32_16x16x32_bf16 v[68:71], v[108:111], v[96:99], v[68:71]
  s_waitcnt lgkmcnt(6)
  buffer_store_dwordx4 v[212:215], v4, s[20:23], s29 offen sc1
  v_mfma_f32_16x16x32_bf16 v[68:71], v[112:115], v[116:119], v[68:71]
  s_waitcnt lgkmcnt(5)
  ds_read_b64 v[132:133], v12 offset:2560
  ds_read_b64 v[134:135], v12 offset:2568
  v_mfma_f32_16x16x32_bf16 v[64:67], v[112:115], v[124:127], v[64:67]
  s_waitcnt lgkmcnt(5)
  ds_read_b64 v[140:141], v12 offset:2048
  ds_read_b64 v[142:143], v12 offset:2056
  v_mfma_f32_16x16x32_bf16 v[60:63], v[112:115], v[136:139], v[60:63]
  s_waitcnt lgkmcnt(6)
  ds_read_b64 v[84:85], v12 offset:3776
  ds_read_b64 v[86:87], v12 offset:3784
  v_mfma_f32_16x16x32_bf16 v[56:59], v[112:115], v[128:131], v[56:59]
  s_waitcnt lgkmcnt(6)
  ds_read_b128 v[80:83], v13 offset:11328
  ds_read_b128 v[92:95], v13 offset:9792
  v_mfma_f32_16x16x32_bf16 v[68:71], v[120:123], v[124:127], v[68:71]
  ds_read_b128 v[88:91], v13 offset:8256
  ds_read_b128 v[104:107], v13 offset:6720
  v_mfma_f32_16x16x32_bf16 v[64:67], v[120:123], v[136:139], v[64:67]
  ds_read_b64 v[100:101], v12 offset:3264
  ds_read_b64 v[102:103], v12 offset:3272
  v_mfma_f32_16x16x32_bf16 v[60:63], v[120:123], v[128:131], v[60:63]
  s_waitcnt lgkmcnt(10)
  ds_read_b128 v[96:99], v13 offset:5184
  ds_read_b64 v[108:109], v12 offset:2752
  v_mfma_f32_16x16x32_bf16 v[68:71], v[132:135], v[136:139], v[68:71]
  buffer_store_dwordx4 v[216:219], v4, s[20:23], s30 offen sc1
  v_mfma_f32_16x16x32_bf16 v[64:67], v[132:135], v[128:131], v[64:67]
  s_waitcnt lgkmcnt(10)
  ds_read_b64 v[110:111], v12 offset:2760
  ds_read_b128 v[116:119], v13 offset:3648
  v_mfma_f32_16x16x32_bf16 v[68:71], v[140:143], v[128:131], v[68:71]
  s_waitcnt lgkmcnt(9)
  ds_read_b64 v[112:113], v12 offset:2240
  ds_read_b64 v[114:115], v12 offset:2248
  v_mfma_f32_16x16x32_bf16 v[236:239], v[84:87], v[80:83], 0
  s_waitcnt lgkmcnt(10)
  v_mfma_f32_16x16x32_bf16 v[232:235], v[84:87], v[92:95], 0
  s_waitcnt lgkmcnt(9)
  ds_read_b128 v[124:127], v13 offset:2112
  v_mfma_f32_16x16x32_bf16 v[228:231], v[84:87], v[88:91], 0
  s_waitcnt lgkmcnt(9)
  ds_write_b128 v253, v[56:59] offset:0
  v_mfma_f32_16x16x32_bf16 v[224:227], v[84:87], v[104:107], 0
  s_waitcnt lgkmcnt(8)
  v_mfma_f32_16x16x32_bf16 v[236:239], v[100:103], v[92:95], v[236:239]
  v_mfma_f32_16x16x32_bf16 v[232:235], v[100:103], v[88:91], v[232:235]
  ds_write_b128 v253, v[60:63] offset:1024
  v_mfma_f32_16x16x32_bf16 v[228:231], v[100:103], v[104:107], v[228:231]
  s_waitcnt lgkmcnt(8)
  buffer_store_dwordx4 v[220:223], v4, s[20:23], s31 offen sc1
  v_mfma_f32_16x16x32_bf16 v[224:227], v[100:103], v[96:99], v[224:227]
  s_waitcnt lgkmcnt(6)
  v_mfma_f32_16x16x32_bf16 v[236:239], v[108:111], v[88:91], v[236:239]
  ds_write_b128 v253, v[64:67] offset:2048
  v_mfma_f32_16x16x32_bf16 v[232:235], v[108:111], v[104:107], v[232:235]
  v_mfma_f32_16x16x32_bf16 v[228:231], v[108:111], v[96:99], v[228:231]
  s_waitcnt lgkmcnt(6)
  ds_read_b64 v[120:121], v12 offset:1728
  ds_read_b64 v[122:123], v12 offset:1736
  v_mfma_f32_16x16x32_bf16 v[224:227], v[108:111], v[116:119], v[224:227]
  s_waitcnt lgkmcnt(6)
  ds_write_b128 v253, v[68:71] offset:3072
  v_mfma_f32_16x16x32_bf16 v[236:239], v[112:115], v[104:107], v[236:239]
  ds_read_b64_tr_b16 v[208:209], v248 offset:0
  v_mfma_f32_16x16x32_bf16 v[232:235], v[112:115], v[96:99], v[232:235]
  ds_read_b128 v[136:139], v13 offset:576
  ds_read_b64_tr_b16 v[210:211], v248 offset:1024
  v_mfma_f32_16x16x32_bf16 v[228:231], v[112:115], v[116:119], v[228:231]
  s_waitcnt lgkmcnt(9)
  ds_read_b64 v[132:133], v12 offset:1216
  ds_read_b64 v[134:135], v12 offset:1224
  v_mfma_f32_16x16x32_bf16 v[224:227], v[112:115], v[124:127], v[224:227]
  s_waitcnt lgkmcnt(6)
  ds_read_b64_tr_b16 v[212:213], v249 offset:0
  ds_read_b64_tr_b16 v[214:215], v249 offset:1024
  v_mfma_f32_16x16x32_bf16 v[236:239], v[120:123], v[96:99], v[236:239]
  ds_read_b64 v[128:129], v12 offset:704
  ds_read_b64 v[130:131], v12 offset:712
  v_mfma_f32_16x16x32_bf16 v[232:235], v[120:123], v[116:119], v[232:235]
  ds_read_b64 v[140:141], v12 offset:192
  ds_read_b64 v[142:143], v12 offset:200
  v_mfma_f32_16x16x32_bf16 v[228:231], v[120:123], v[124:127], v[228:231]
  s_waitcnt lgkmcnt(9)
  ds_read_b64 v[80:81], v12 offset:3712
  ds_read_b64 v[82:83], v12 offset:3720
  v_mfma_f32_16x16x32_bf16 v[224:227], v[120:123], v[136:139], v[224:227]
  s_waitcnt lgkmcnt(8)
  ds_read_b128 v[84:87], v13 offset:11136
  ds_read_b128 v[92:95], v13 offset:9600
  v_mfma_f32_16x16x32_bf16 v[236:239], v[132:135], v[116:119], v[236:239]
  s_waitcnt vmcnt(8)
  s_waitcnt lgkmcnt(8)
  s_barrier
  ds_read_b128 v[152:155], v16 offset:0
  ds_read_b128 v[156:159], v17 offset:0
  v_mfma_f32_16x16x32_bf16 v[232:235], v[132:135], v[124:127], v[232:235]
  ds_read_b128 v[100:103], v13 offset:8064
  ds_read_b128 v[88:91], v13 offset:6528
  ds_read_b128 v[160:163], v200 offset:0
  ds_read_b128 v[164:167], v201 offset:0
  v_mfma_f32_16x16x32_bf16 v[228:231], v[132:135], v[136:139], v[228:231]
  s_waitcnt lgkmcnt(12)
  ds_read_b64 v[108:109], v12 offset:3200
  ds_read_b64 v[110:111], v12 offset:3208
  ds_read_b128 v[168:171], v202 offset:0
  ds_read_b128 v[56:59], v250 offset:0
  v_mfma_f32_16x16x32_bf16 v[236:239], v[128:131], v[124:127], v[236:239]
  ds_read_b128 v[104:107], v13 offset:4992
  ds_read_b64 v[112:113], v12 offset:2688
  ds_read_b128 v[60:63], v250 offset:256
  ds_read_b128 v[64:67], v250 offset:4096
  v_mfma_f32_16x16x32_bf16 v[232:235], v[128:131], v[136:139], v[232:235]
  s_waitcnt lgkmcnt(14)
  ds_read_b64 v[114:115], v12 offset:2696
  ds_read_b128 v[96:99], v13 offset:3456
  ds_read_b128 v[68:71], v250 offset:4352
  ds_read_b64 v[184:185], v19 offset:0
  v_mfma_f32_16x16x32_bf16 v[236:239], v[140:143], v[136:139], v[236:239]
  ds_read_b64 v[120:121], v12 offset:2176
  ds_read_b64 v[122:123], v12 offset:2184
  ds_read_b64 v[186:187], v19 offset:2048
  ds_read_b64 v[188:189], v19 offset:4096
  v_mfma_f32_16x16x32_bf16 v[236:239], v[80:83], v[84:87], v[236:239]
  ds_read_b64 v[190:191], v19 offset:6144
  ds_read_b32 v192, v20 offset:0
  ds_read_b64 v[194:195], v21 offset:0
  ds_read_b64 v[196:197], v203 offset:0
  v_mfma_f32_16x16x32_bf16 v[232:235], v[80:83], v[92:95], v[232:235]
  s_waitcnt lgkmcnt(14)
  ds_read_b128 v[116:119], v13 offset:1920
  v_mfma_f32_16x16x32_bf16 v[228:231], v[80:83], v[100:103], v[228:231]
  ds_read_b64 v[132:133], v12 offset:1664
  ds_read_b64 v[134:135], v12 offset:1672
  v_lshlrev_b32 v172, 16, v152
  v_and_b32 v173, 0xffff0000, v152
  v_mfma_f32_16x16x32_bf16 v[224:227], v[80:83], v[88:91], v[224:227]
  v_lshlrev_b32 v174, 16, v153
  v_and_b32 v175, 0xffff0000, v153
  v_lshlrev_b32 v176, 16, v154
  v_and_b32 v177, 0xffff0000, v154
  v_mfma_f32_16x16x32_bf16 v[236:239], v[108:111], v[92:95], v[236:239]
  v_lshlrev_b32 v178, 16, v155
  v_and_b32 v179, 0xffff0000, v155
  v_fma_f32 v156, v172, v156, v164
  v_fma_f32 v157, v173, v157, v165
  v_mfma_f32_16x16x32_bf16 v[232:235], v[108:111], v[100:103], v[232:235]
  ds_read_b128 v[124:127], v13 offset:384
  v_fma_f32 v158, v174, v158, v166
  v_fma_f32 v159, v175, v159, v167
  v_fma_f32 v160, v176, v160, v168
  v_mfma_f32_16x16x32_bf16 v[228:231], v[108:111], v[88:91], v[228:231]
  ds_read_b64 v[128:129], v12 offset:1152
  ds_read_b64 v[130:131], v12 offset:1160
  v_fma_f32 v161, v177, v161, v169
  v_fma_f32 v162, v178, v162, v170
  v_mfma_f32_16x16x32_bf16 v[224:227], v[108:111], v[104:107], v[224:227]
  s_waitcnt lgkmcnt(14)
  s_waitcnt lgkmcnt(6)
  v_fma_f32 v163, v179, v163, v171
  v_add_f32 v56, v56, v64
  v_add_f32 v57, v57, v65
  v_mfma_f32_16x16x32_bf16 v[236:239], v[112:115], v[100:103], v[236:239]
  v_add_f32 v58, v58, v66
  v_add_f32 v59, v59, v67
  v_add_f32 v60, v60, v68
  v_add_f32 v61, v61, v69
  v_mfma_f32_16x16x32_bf16 v[232:235], v[112:115], v[88:91], v[232:235]
  ds_read_b64 v[136:137], v12 offset:640
  ds_read_b64 v[138:139], v12 offset:648
  v_add_f32 v62, v62, v70
  v_add_f32 v63, v63, v71
  v_mfma_f32_16x16x32_bf16 v[228:231], v[112:115], v[104:107], v[228:231]
  v_fmac_f32 v172, v156, v56
  v_fmac_f32 v173, v157, v57
  v_fmac_f32 v174, v158, v58
  v_fmac_f32 v175, v159, v59
  v_mfma_f32_16x16x32_bf16 v[224:227], v[112:115], v[96:99], v[224:227]
  ds_read_b64 v[140:141], v12 offset:128
  ds_read_b64 v[142:143], v12 offset:136
  v_fmac_f32 v176, v160, v60
  v_fmac_f32 v177, v161, v61
  v_mfma_f32_16x16x32_bf16 v[236:239], v[120:123], v[88:91], v[236:239]
  ds_read_b64 v[84:85], v14 offset:3648
  ds_read_b64 v[86:87], v14 offset:3656
  v_fmac_f32 v178, v162, v62
  v_fmac_f32 v179, v163, v63
  v_mfma_f32_16x16x32_bf16 v[232:235], v[120:123], v[104:107], v[232:235]
  ds_read_b128 v[80:83], v15 offset:10944
  ds_read_b128 v[92:95], v15 offset:6336
  v_cvt_pk_bf16_f32 v144, v172, v173
  v_cvt_pk_bf16_f32 v145, v174, v175
  v_mfma_f32_16x16x32_bf16 v[228:231], v[120:123], v[96:99], v[228:231]
  s_waitcnt lgkmcnt(13)
  ds_read_b64 v[108:109], v14 offset:3136
  ds_read_b64 v[110:111], v14 offset:3144
  v_cvt_pk_bf16_f32 v146, v176, v177
  v_cvt_pk_bf16_f32 v147, v178, v179
  v_mfma_f32_16x16x32_bf16 v[224:227], v[120:123], v[116:119], v[224:227]
  s_waitcnt lgkmcnt(13)
  buffer_store_dwordx4 v[144:147], v18, s[20:23], s13 offen sc1
  v_add_f32 v184, v184, v186
  v_add_f32 v188, v188, v190
  v_mfma_f32_16x16x32_bf16 v[236:239], v[132:135], v[104:107], v[236:239]
  ds_read_b128 v[100:103], v15 offset:9408
  ds_read_b128 v[112:115], v15 offset:4800
  v_add_f32 v185, v185, v187
  v_add_f32 v189, v189, v191
  v_mfma_f32_16x16x32_bf16 v[232:235], v[132:135], v[96:99], v[232:235]
  ds_read_b64 v[88:89], v14 offset:2624
  ds_read_b64 v[90:91], v14 offset:2632
  v_lshlrev_b32 v198, 16, v192
  v_and_b32 v199, 0xffff0000, v192
  v_mfma_f32_16x16x32_bf16 v[228:231], v[132:135], v[116:119], v[228:231]
  s_waitcnt lgkmcnt(14)
  ds_read_b128 v[120:123], v15 offset:7872
  ds_read_b128 v[104:107], v15 offset:3264
  v_add_f32 v184, v184, v188
  v_fma_f32 v194, v198, v194, v196
  v_mfma_f32_16x16x32_bf16 v[224:227], v[132:135], v[124:127], v[224:227]
  ds_read_b64 v[132:133], v14 offset:2112
  ds_read_b64 v[134:135], v14 offset:2120
  v_add_f32 v185, v185, v189
  v_fma_f32 v195, v199, v195, v197
  v_mfma_f32_16x16x32_bf16 v[236:239], v[128:131], v[96:99], v[236:239]
  ds_read_b128 v[96:99], v15 offset:1728
  v_fmac_f32 v198, v194, v184
  v_fmac_f32 v199, v195, v185
  v_cvt_pk_bf16_f32 v192, v198, v199
  v_mfma_f32_16x16x32_bf16 v[232:235], v[128:131], v[116:119], v[232:235]
  buffer_store_dword v192, v22, s[20:23], s14 offen sc1
  v_mfma_f32_16x16x32_bf16 v[228:231], v[128:131], v[124:127], v[228:231]
  s_waitcnt lgkmcnt(14)
  ds_read_b64 v[128:129], v14 offset:1600
  ds_read_b64 v[130:131], v14 offset:1608
  v_mfma_f32_16x16x32_bf16 v[236:239], v[136:139], v[116:119], v[236:239]
  ds_read_b128 v[116:119], v15 offset:192
  v_mfma_f32_16x16x32_bf16 v[232:235], v[136:139], v[124:127], v[232:235]
  s_waitcnt vmcnt(2)
  s_barrier
  ds_read_b64 v[136:137], v14 offset:1088
  v_mfma_f32_16x16x32_bf16 v[236:239], v[140:143], v[124:127], v[236:239]
  s_waitcnt lgkmcnt(14)
  buffer_atomic_add v7, v5, s[20:23], 0 offen offset:256 sc1
  v_mfma_f32_16x16x32_bf16 v[76:79], v[84:87], v[80:83], 0
  ds_read_b64 v[138:139], v14 offset:1096
  ds_read_b64 v[124:125], v14 offset:576
  v_mfma_f32_16x16x32_bf16 v[72:75], v[84:87], v[92:95], 0
  s_waitcnt lgkmcnt(14)
  ds_read_b64 v[126:127], v14 offset:584
  ds_read_b64 v[140:141], v14 offset:64
  v_mfma_f32_16x16x32_bf16 v[76:79], v[108:111], v[100:103], v[76:79]
  s_waitcnt lgkmcnt(14)
  buffer_store_dwordx4 v[208:211], v4, s[20:23], s6 offen sc1
  v_mfma_f32_16x16x32_bf16 v[72:75], v[108:111], v[112:115], v[72:75]
  s_waitcnt lgkmcnt(12)
  ds_read_b64 v[142:143], v14 offset:72
  ds_read_b64 v[80:81], v14 offset:3584
  v_mfma_f32_16x16x32_bf16 v[76:79], v[88:91], v[120:123], v[76:79]
  s_waitcnt lgkmcnt(13)
  ds_read_b64 v[82:83], v14 offset:3592
  ds_read_b128 v[84:87], v15 offset:10752
  v_mfma_f32_16x16x32_bf16 v[72:75], v[88:91], v[104:107], v[72:75]
  s_waitcnt lgkmcnt(13)
  ds_read_b128 v[100:103], v15 offset:6144
  ds_read_b64 v[108:109], v14 offset:3072
  v_mfma_f32_16x16x32_bf16 v[76:79], v[132:135], v[92:95], v[76:79]
  s_waitcnt lgkmcnt(14)
  ds_read_b64 v[110:111], v14 offset:3080
  ds_read_b128 v[120:123], v15 offset:9216
  v_mfma_f32_16x16x32_bf16 v[72:75], v[132:135], v[96:99], v[72:75]
  s_waitcnt lgkmcnt(14)
  ds_read_b128 v[88:91], v15 offset:4608
  ds_read_b64 v[92:93], v14 offset:2560
  v_mfma_f32_16x16x32_bf16 v[76:79], v[128:131], v[112:115], v[76:79]
  s_waitcnt lgkmcnt(14)
  buffer_store_dwordx4 v[212:215], v4, s[20:23], s7 offen sc1
  v_mfma_f32_16x16x32_bf16 v[72:75], v[128:131], v[116:119], v[72:75]
  s_waitcnt lgkmcnt(13)
  ds_read_b64 v[94:95], v14 offset:2568
  ds_read_b128 v[132:135], v15 offset:7680
  v_mfma_f32_16x16x32_bf16 v[76:79], v[136:139], v[104:107], v[76:79]
  s_waitcnt lgkmcnt(13)
  ds_read_b128 v[112:115], v15 offset:3072
  ds_read_b64 v[128:129], v14 offset:2048
  v_mfma_f32_16x16x32_bf16 v[76:79], v[124:127], v[96:99], v[76:79]
  s_waitcnt lgkmcnt(13)
  ds_read_b64 v[130:131], v14 offset:2056
  ds_read_b128 v[104:107], v15 offset:1536
  v_mfma_f32_16x16x32_bf16 v[76:79], v[140:143], v[116:119], v[76:79]
  s_waitcnt lgkmcnt(12)
  ds_read_b64 v[136:137], v14 offset:1536
  ds_read_b64 v[138:139], v14 offset:1544
  v_mfma_f32_16x16x32_bf16 v[76:79], v[80:83], v[84:87], v[76:79]
  s_waitcnt lgkmcnt(13)
  ds_read_b128 v[96:99], v15 offset:0
  ds_read_b64 v[124:125], v14 offset:1024
  v_mfma_f32_16x16x32_bf16 v[72:75], v[80:83], v[100:103], v[72:75]
  s_waitcnt lgkmcnt(12)
  ds_read_b64 v[126:127], v14 offset:1032
  ds_read_b64 v[116:117], v14 offset:512
  v_mfma_f32_16x16x32_bf16 v[76:79], v[108:111], v[120:123], v[76:79]
  s_waitcnt lgkmcnt(13)
  ds_read_b64 v[118:119], v14 offset:520
  ds_read_b64 v[140:141], v14 offset:0
  v_mfma_f32_16x16x32_bf16 v[72:75], v[108:111], v[88:91], v[72:75]
  s_waitcnt lgkmcnt(12)
  ds_read_b64 v[142:143], v14 offset:8
  ds_read_b64 v[84:85], v12 offset:3648
  v_mfma_f32_16x16x32_bf16 v[76:79], v[92:95], v[132:135], v[76:79]
  s_waitcnt lgkmcnt(13)
  ds_read_b64 v[86:87], v12 offset:3656
  ds_read_b128 v[80:83], v13 offset:10944
  v_mfma_f32_16x16x32_bf16 v[72:75], v[92:95], v[112:115], v[72:75]
  s_waitcnt lgkmcnt(13)
  ds_read_b128 v[120:123], v13 offset:9408
  ds_read_b128 v[108:111], v13 offset:7872
  v_mfma_f32_16x16x32_bf16 v[76:79], v[128:131], v[100:103], v[76:79]
  s_waitcnt lgkmcnt(14)
  ds_read_b128 v[132:135], v13 offset:6336
  ds_read_b64 v[92:93], v12 offset:3136
  v_mfma_f32_16x16x32_bf16 v[72:75], v[128:131], v[104:107], v[72:75]
  s_waitcnt lgkmcnt(14)
  ds_read_b64 v[94:95], v12 offset:3144
  ds_read_b128 v[100:103], v13 offset:4800
  v_mfma_f32_16x16x32_bf16 v[76:79], v[136:139], v[88:91], v[76:79]
  s_waitcnt lgkmcnt(14)
  ds_read_b64 v[128:129], v12 offset:2624
  ds_read_b64 v[130:131], v12 offset:2632
  v_mfma_f32_16x16x32_bf16 v[72:75], v[136:139], v[96:99], v[72:75]
  s_waitcnt lgkmcnt(14)
  v_mfma_f32_16x16x32_bf16 v[76:79], v[124:127], v[112:115], v[76:79]
  s_waitcnt lgkmcnt(13)
  ds_read_b128 v[88:91], v13 offset:3264
  v_mfma_f32_16x16x32_bf16 v[76:79], v[116:119], v[104:107], v[76:79]
  s_waitcnt lgkmcnt(12)
  ds_read_b64 v[136:137], v12 offset:2112
  ds_read_b64 v[138:139], v12 offset:2120
  v_mfma_f32_16x16x32_bf16 v[76:79], v[140:143], v[96:99], v[76:79]
  s_waitcnt lgkmcnt(11)
  v_mfma_f32_16x16x32_bf16 v[236:239], v[84:87], v[80:83], v[236:239]
  s_waitcnt lgkmcnt(10)
  v_mfma_f32_16x16x32_bf16 v[232:235], v[84:87], v[120:123], v[232:235]
  s_waitcnt lgkmcnt(9)
  ds_write_b128 v25, v[72:75] offset:24576
  v_mfma_f32_16x16x32_bf16 v[228:231], v[84:87], v[108:111], v[228:231]
  s_waitcnt lgkmcnt(9)
  v_mfma_f32_16x16x32_bf16 v[224:227], v[84:87], v[132:135], v[224:227]
  s_waitcnt lgkmcnt(7)
  v_mfma_f32_16x16x32_bf16 v[236:239], v[92:95], v[120:123], v[236:239]
  ds_write_b128 v25, v[76:79] offset:25600
  v_mfma_f32_16x16x32_bf16 v[232:235], v[92:95], v[108:111], v[232:235]
  v_mfma_f32_16x16x32_bf16 v[228:231], v[92:95], v[132:135], v[228:231]
  s_waitcnt lgkmcnt(7)
  v_mfma_f32_16x16x32_bf16 v[224:227], v[92:95], v[100:103], v[224:227]
  s_waitcnt lgkmcnt(5)
  ds_read_b128 v[112:115], v13 offset:1728
  ds_read_b64 v[124:125], v12 offset:1600
  v_mfma_f32_16x16x32_bf16 v[236:239], v[128:131], v[108:111], v[236:239]
  ds_read_b64 v[126:127], v12 offset:1608
  ds_read_b128 v[104:107], v13 offset:192
  v_mfma_f32_16x16x32_bf16 v[232:235], v[128:131], v[132:135], v[232:235]
  ds_read_b64 v[116:117], v12 offset:1088
  ds_read_b64 v[118:119], v12 offset:1096
  v_mfma_f32_16x16x32_bf16 v[228:231], v[128:131], v[100:103], v[228:231]
  s_waitcnt lgkmcnt(10)
  ds_read_b64 v[96:97], v12 offset:576
  ds_read_b64 v[98:99], v12 offset:584
  v_mfma_f32_16x16x32_bf16 v[224:227], v[128:131], v[88:91], v[224:227]
  s_waitcnt lgkmcnt(10)
  ds_read_b64 v[140:141], v12 offset:64
  ds_read_b64 v[142:143], v12 offset:72
  v_mfma_f32_16x16x32_bf16 v[236:239], v[136:139], v[132:135], v[236:239]
  ds_read_b64 v[80:81], v12 offset:3584
  ds_read_b64 v[82:83], v12 offset:3592
  v_mfma_f32_16x16x32_bf16 v[232:235], v[136:139], v[100:103], v[232:235]
  ds_read_b128 v[84:87], v13 offset:10752
  ds_read_b128 v[120:123], v13 offset:9216
  v_mfma_f32_16x16x32_bf16 v[228:231], v[136:139], v[88:91], v[228:231]
  s_waitcnt lgkmcnt(13)
  ds_read_b128 v[92:95], v13 offset:7680
  v_mfma_f32_16x16x32_bf16 v[224:227], v[136:139], v[112:115], v[224:227]
  s_waitcnt lgkmcnt(12)
  ds_read_b128 v[108:111], v13 offset:6144
  v_mfma_f32_16x16x32_bf16 v[236:239], v[124:127], v[100:103], v[236:239]
  s_waitcnt vmcnt(0)
  s_barrier
  ds_read_b64 v[128:129], v12 offset:3072
  v_mfma_f32_16x16x32_bf16 v[232:235], v[124:127], v[88:91], v[232:235]
  buffer_atomic_add v7, v5, s[20:23], 0 offen offset:512 sc1
  v_mfma_f32_16x16x32_bf16 v[228:231], v[124:127], v[112:115], v[228:231]
  s_waitcnt lgkmcnt(13)
  s_add_u32 s13, s13, 1314816
  ds_read_b64 v[130:131], v12 offset:3080
  v_mfma_f32_16x16x32_bf16 v[224:227], v[124:127], v[104:107], v[224:227]
  s_waitcnt lgkmcnt(12)
  s_add_u32 s14, s14, 1314816
  ds_read_b128 v[132:135], v13 offset:4608
  v_mfma_f32_16x16x32_bf16 v[236:239], v[116:119], v[88:91], v[236:239]
  ds_read_b64 v[136:137], v12 offset:2560
  ds_read_b64 v[138:139], v12 offset:2568
  v_mfma_f32_16x16x32_bf16 v[232:235], v[116:119], v[112:115], v[232:235]
  ds_read_b128 v[152:155], v16 offset:6144
  ds_read_b128 v[156:159], v17 offset:8192
  v_mfma_f32_16x16x32_bf16 v[228:231], v[116:119], v[104:107], v[228:231]
  s_waitcnt lgkmcnt(14)
  buffer_load_dword v8, v6, s[20:23], 0 offen offset:256 sc1
  v_mfma_f32_16x16x32_bf16 v[236:239], v[96:99], v[112:115], v[236:239]
  ds_read_b128 v[100:103], v13 offset:3072
  ds_read_b128 v[160:163], v200 offset:8192
  v_mfma_f32_16x16x32_bf16 v[232:235], v[96:99], v[104:107], v[232:235]
  s_waitcnt lgkmcnt(14)
  ds_read_b64 v[124:125], v12 offset:2048
  ds_read_b64 v[126:127], v12 offset:2056
  v_mfma_f32_16x16x32_bf16 v[236:239], v[140:143], v[104:107], v[236:239]
  s_waitcnt lgkmcnt(14)
  ds_read_b128 v[164:167], v201 offset:8192
  ds_read_b128 v[168:171], v202 offset:8192
  v_mfma_f32_16x16x32_bf16 v[236:239], v[80:83], v[84:87], v[236:239]
  s_waitcnt lgkmcnt(14)
  ds_read_b64 v[184:185], v19 offset:8192
  ds_read_b64 v[186:187], v19 offset:10240
  v_mfma_f32_16x16x32_bf16 v[232:235], v[80:83], v[120:123], v[232:235]
  ds_read_b128 v[88:91], v13 offset:1536
  ds_read_b64 v[188:189], v19 offset:12288
  v_mfma_f32_16x16x32_bf16 v[228:231], v[80:83], v[92:95], v[228:231]
  s_waitcnt lgkmcnt(14)
  ds_read_b64 v[116:117], v12 offset:1536
  ds_read_b64 v[118:119], v12 offset:1544
  v_mfma_f32_16x16x32_bf16 v[224:227], v[80:83], v[108:111], v[224:227]
  ds_read_b64 v[190:191], v19 offset:14336
  ds_read_b32 v192, v20 offset:6144
  v_mfma_f32_16x16x32_bf16 v[236:239], v[128:131], v[120:123], v[236:239]
  ds_read_b64 v[194:195], v21 offset:8192
  ds_read_b64 v[196:197], v203 offset:8192
  v_mfma_f32_16x16x32_bf16 v[232:235], v[128:131], v[92:95], v[232:235]
  s_waitcnt lgkmcnt(10)
  ds_read_b128 v[112:115], v13 offset:0
  v_lshlrev_b32 v172, 16, v152
  v_mfma_f32_16x16x32_bf16 v[228:231], v[128:131], v[108:111], v[228:231]
  ds_read_b64 v[96:97], v12 offset:1024
  ds_read_b64 v[98:99], v12 offset:1032
  v_mfma_f32_16x16x32_bf16 v[224:227], v[128:131], v[132:135], v[224:227]
  v_and_b32 v173, 0xffff0000, v152
  v_lshlrev_b32 v174, 16, v153
  v_mfma_f32_16x16x32_bf16 v[236:239], v[136:139], v[92:95], v[236:239]
  v_and_b32 v175, 0xffff0000, v153
  v_lshlrev_b32 v176, 16, v154
  v_mfma_f32_16x16x32_bf16 v[232:235], v[136:139], v[108:111], v[232:235]
  ds_read_b64 v[104:105], v12 offset:512
  ds_read_b64 v[106:107], v12 offset:520
  v_mfma_f32_16x16x32_bf16 v[228:231], v[136:139], v[132:135], v[228:231]
  v_and_b32 v177, 0xffff0000, v154
  v_lshlrev_b32 v178, 16, v155
  v_mfma_f32_16x16x32_bf16 v[224:227], v[136:139], v[100:103], v[224:227]
  ds_read_b64 v[140:141], v12 offset:0
  ds_read_b64 v[142:143], v12 offset:8
  v_mfma_f32_16x16x32_bf16 v[236:239], v[124:127], v[108:111], v[236:239]
  v_and_b32 v179, 0xffff0000, v155
  v_fma_f32 v156, v172, v156, v164
  v_mfma_f32_16x16x32_bf16 v[232:235], v[124:127], v[132:135], v[232:235]
  v_fma_f32 v157, v173, v157, v165
  v_fma_f32 v158, v174, v158, v166
  v_mfma_f32_16x16x32_bf16 v[228:231], v[124:127], v[100:103], v[228:231]
  s_waitcnt lgkmcnt(14)
  v_fma_f32 v159, v175, v159, v167
  v_fma_f32 v160, v176, v160, v168
  v_mfma_f32_16x16x32_bf16 v[224:227], v[124:127], v[88:91], v[224:227]
  s_waitcnt lgkmcnt(11)
  v_fma_f32 v161, v177, v161, v169
  v_fma_f32 v162, v178, v162, v170
  v_mfma_f32_16x16x32_bf16 v[236:239], v[116:119], v[132:135], v[236:239]
  s_waitcnt lgkmcnt(7)
  v_fma_f32 v163, v179, v163, v171
  v_add_f32 v184, v184, v186
  v_mfma_f32_16x16x32_bf16 v[232:235], v[116:119], v[100:103], v[232:235]
  v_add_f32 v188, v188, v190
  v_add_f32 v185, v185, v187
  v_mfma_f32_16x16x32_bf16 v[228:231], v[116:119], v[88:91], v[228:231]
  s_waitcnt lgkmcnt(6)
  v_add_f32 v189, v189, v191
  v_lshlrev_b32 v198, 16, v192
  v_mfma_f32_16x16x32_bf16 v[224:227], v[116:119], v[112:115], v[224:227]
  s_waitcnt lgkmcnt(4)
  v_and_b32 v199, 0xffff0000, v192
  v_add_f32 v184, v184, v188
  v_mfma_f32_16x16x32_bf16 v[236:239], v[96:99], v[100:103], v[236:239]
  v_fma_f32 v194, v198, v194, v196
  v_add_f32 v185, v185, v189
  v_mfma_f32_16x16x32_bf16 v[232:235], v[96:99], v[88:91], v[232:235]
  v_fma_f32 v195, v199, v195, v197
  v_fmac_f32 v198, v194, v184
  v_mfma_f32_16x16x32_bf16 v[228:231], v[96:99], v[112:115], v[228:231]
  s_waitcnt lgkmcnt(2)
  v_fmac_f32 v199, v195, v185
  v_cvt_pk_bf16_f32 v192, v198, v199
  v_mfma_f32_16x16x32_bf16 v[236:239], v[104:107], v[88:91], v[236:239]
  buffer_store_dword v192, v22, s[20:23], s14 offen sc1
  v_mfma_f32_16x16x32_bf16 v[232:235], v[104:107], v[112:115], v[232:235]
  s_waitcnt lgkmcnt(0)
  v_mfma_f32_16x16x32_bf16 v[236:239], v[140:143], v[112:115], v[236:239]
  s_branch j_12
e_11:
  ds_read_b64 v[80:81], v14 offset:3648
  ds_read_b64 v[82:83], v14 offset:3656
  ds_read_b128 v[84:87], v15 offset:3264
  ds_read_b128 v[88:91], v15 offset:1728
  ds_read_b64 v[92:93], v14 offset:3136
  ds_read_b64 v[94:95], v14 offset:3144
  ds_read_b128 v[96:99], v15 offset:192
  ds_read_b64 v[100:101], v14 offset:2624
  ds_read_b64 v[102:103], v14 offset:2632
  ds_read_b64 v[104:105], v14 offset:3584
  ds_read_b64 v[106:107], v14 offset:3592
  ds_read_b128 v[108:111], v15 offset:3072
  s_waitcnt lgkmcnt(9)
  v_mfma_f32_16x16x32_bf16 v[76:79], v[80:83], v[84:87], 0
  s_waitcnt lgkmcnt(8)
  ds_read_b128 v[112:115], v15 offset:1536
  ds_read_b64 v[116:117], v14 offset:3072
  v_mfma_f32_16x16x32_bf16 v[72:75], v[80:83], v[88:91], 0
  s_waitcnt lgkmcnt(8)
  ds_read_b64 v[118:119], v14 offset:3080
  ds_read_b128 v[120:123], v15 offset:0
  v_mfma_f32_16x16x32_bf16 v[76:79], v[92:95], v[88:91], v[76:79]
  s_waitcnt lgkmcnt(9)
  ds_read_b64 v[124:125], v14 offset:2560
  ds_read_b64 v[126:127], v14 offset:2568
  v_mfma_f32_16x16x32_bf16 v[72:75], v[92:95], v[96:99], v[72:75]
  s_waitcnt lgkmcnt(9)
  ds_read_b64 v[128:129], v12 offset:3776
  ds_read_b64 v[130:131], v12 offset:3784
  v_mfma_f32_16x16x32_bf16 v[76:79], v[100:103], v[96:99], v[76:79]
  s_waitcnt lgkmcnt(8)
  s_mov_b32 m0, s11
  s_nop 0
  buffer_load_dwordx4 v4, s[20:23], s12 offen offset:0 sc1 lds
  ds_read_b128 v[132:135], v13 offset:5184
  v_mfma_f32_16x16x32_bf16 v[76:79], v[104:107], v[108:111], v[76:79]
  s_waitcnt lgkmcnt(8)
  ds_read_b128 v[136:139], v13 offset:3648
  ds_read_b128 v[140:143], v13 offset:2112
  v_mfma_f32_16x16x32_bf16 v[72:75], v[104:107], v[112:115], v[72:75]
  s_waitcnt lgkmcnt(8)
  buffer_load_dwordx4 v4, s[20:23], s12 offen offset:1024 sc1 lds
  v_mfma_f32_16x16x32_bf16 v[76:79], v[116:119], v[112:115], v[76:79]
  s_waitcnt lgkmcnt(7)
  ds_read_b128 v[84:87], v13 offset:576
  ds_read_b64 v[80:81], v12 offset:3264
  v_mfma_f32_16x16x32_bf16 v[72:75], v[116:119], v[120:123], v[72:75]
  s_waitcnt lgkmcnt(7)
  ds_read_b64 v[82:83], v12 offset:3272
  ds_read_b64 v[88:89], v12 offset:2752
  v_mfma_f32_16x16x32_bf16 v[76:79], v[124:127], v[120:123], v[76:79]
  s_waitcnt lgkmcnt(6)
  buffer_load_dwordx4 v4, s[20:23], s12 offen offset:2048 sc1 lds
  v_mfma_f32_16x16x32_bf16 v[68:71], v[128:131], v[132:135], 0
  s_waitcnt lgkmcnt(5)
  ds_read_b64 v[90:91], v12 offset:2760
  ds_read_b64 v[92:93], v12 offset:2240
  v_mfma_f32_16x16x32_bf16 v[64:67], v[128:131], v[136:139], 0
  s_waitcnt lgkmcnt(6)
  buffer_load_dwordx4 v4, s[20:23], s12 offen offset:3072 sc1 lds
  v_mfma_f32_16x16x32_bf16 v[60:63], v[128:131], v[140:143], 0
  s_waitcnt lgkmcnt(5)
  ds_read_b64 v[94:95], v12 offset:2248
  ds_read_b64 v[96:97], v12 offset:3712
  v_mfma_f32_16x16x32_bf16 v[56:59], v[128:131], v[84:87], 0
  s_waitcnt lgkmcnt(5)
  ds_read_b64 v[98:99], v12 offset:3720
  ds_read_b128 v[100:103], v13 offset:4992
  v_mfma_f32_16x16x32_bf16 v[68:71], v[80:83], v[136:139], v[68:71]
  ds_read_b128 v[108:111], v13 offset:3456
  ds_read_b128 v[104:107], v13 offset:1920
  v_mfma_f32_16x16x32_bf16 v[64:67], v[80:83], v[140:143], v[64:67]
  ds_read_b128 v[112:115], v13 offset:384
  ds_read_b64 v[116:117], v12 offset:3200
  v_mfma_f32_16x16x32_bf16 v[60:63], v[80:83], v[84:87], v[60:63]
  s_waitcnt lgkmcnt(9)
  ds_read_b64 v[118:119], v12 offset:3208
  ds_read_b64 v[120:121], v12 offset:2688
  v_mfma_f32_16x16x32_bf16 v[68:71], v[88:91], v[140:143], v[68:71]
  ds_read_b64 v[122:123], v12 offset:2696
  ds_read_b64 v[124:125], v12 offset:2176
  v_mfma_f32_16x16x32_bf16 v[64:67], v[88:91], v[84:87], v[64:67]
  s_waitcnt lgkmcnt(11)
  ds_read_b64 v[126:127], v12 offset:2184
  ds_read_b64 v[132:133], v12 offset:3648
  v_mfma_f32_16x16x32_bf16 v[68:71], v[92:95], v[84:87], v[68:71]
  s_waitcnt lgkmcnt(10)
  ds_read_b64 v[134:135], v12 offset:3656
  ds_read_b128 v[128:131], v13 offset:4800
  v_mfma_f32_16x16x32_bf16 v[68:71], v[96:99], v[100:103], v[68:71]
  s_waitcnt lgkmcnt(11)
  ds_read_b128 v[136:139], v13 offset:3264
  ds_read_b128 v[80:83], v13 offset:1728
  v_mfma_f32_16x16x32_bf16 v[64:67], v[96:99], v[108:111], v[64:67]
  s_waitcnt lgkmcnt(12)
  ds_read_b128 v[140:143], v13 offset:192
  ds_read_b64 v[88:89], v12 offset:3136
  v_mfma_f32_16x16x32_bf16 v[60:63], v[96:99], v[104:107], v[60:63]
  s_waitcnt lgkmcnt(13)
  ds_read_b64 v[90:91], v12 offset:3144
  v_mfma_f32_16x16x32_bf16 v[56:59], v[96:99], v[112:115], v[56:59]
  s_waitcnt lgkmcnt(12)
  ds_read_b64 v[84:85], v12 offset:2624
  ds_read_b64 v[86:87], v12 offset:2632
  v_mfma_f32_16x16x32_bf16 v[68:71], v[116:119], v[108:111], v[68:71]
  buffer_store_dwordx4 v[224:227], v254, s[20:23], s32 offen sc1
  v_mfma_f32_16x16x32_bf16 v[64:67], v[116:119], v[104:107], v[64:67]
  buffer_store_dwordx4 v[228:231], v254, s[20:23], s33 offen sc1
  v_mfma_f32_16x16x32_bf16 v[60:63], v[116:119], v[112:115], v[60:63]
  s_waitcnt lgkmcnt(12)
  buffer_store_dwordx4 v[232:235], v254, s[20:23], s34 offen sc1
  v_mfma_f32_16x16x32_bf16 v[68:71], v[120:123], v[104:107], v[68:71]
  buffer_store_dwordx4 v[236:239], v254, s[20:23], s35 offen sc1
  v_mfma_f32_16x16x32_bf16 v[64:67], v[120:123], v[112:115], v[64:67]
  s_waitcnt lgkmcnt(10)
  ds_read_b64 v[92:93], v12 offset:2112
  ds_read_b64 v[94:95], v12 offset:2120
  v_mfma_f32_16x16x32_bf16 v[68:71], v[124:127], v[112:115], v[68:71]
  s_waitcnt lgkmcnt(9)
  buffer_store_dwordx4 v[208:211], v4, s[20:23], s28 offen sc1
  v_mfma_f32_16x16x32_bf16 v[68:71], v[132:135], v[128:131], v[68:71]
  s_waitcnt lgkmcnt(8)
  ds_write_b128 v25, v[72:75] offset:16384
  v_mfma_f32_16x16x32_bf16 v[64:67], v[132:135], v[136:139], v[64:67]
  s_waitcnt lgkmcnt(8)
  v_mfma_f32_16x16x32_bf16 v[60:63], v[132:135], v[80:83], v[60:63]
  s_waitcnt lgkmcnt(7)
  v_mfma_f32_16x16x32_bf16 v[56:59], v[132:135], v[140:143], v[56:59]
  s_waitcnt lgkmcnt(5)
  ds_read_b64 v[100:101], v12 offset:3584
  ds_read_b64 v[102:103], v12 offset:3592
  v_mfma_f32_16x16x32_bf16 v[68:71], v[88:91], v[136:139], v[68:71]
  ds_read_b128 v[96:99], v13 offset:4608
  ds_read_b128 v[108:111], v13 offset:3072
  v_mfma_f32_16x16x32_bf16 v[64:67], v[88:91], v[80:83], v[64:67]
  ds_write_b128 v25, v[76:79] offset:17408
  v_mfma_f32_16x16x32_bf16 v[60:63], v[88:91], v[140:143], v[60:63]
  s_waitcnt lgkmcnt(8)
  ds_read_b128 v[116:119], v13 offset:1536
  v_mfma_f32_16x16x32_bf16 v[68:71], v[84:87], v[80:83], v[68:71]
  ds_read_b128 v[104:107], v13 offset:0
  v_mfma_f32_16x16x32_bf16 v[64:67], v[84:87], v[140:143], v[64:67]
  s_waitcnt lgkmcnt(8)
  ds_read_b64 v[120:121], v12 offset:3072
  ds_read_b64 v[122:123], v12 offset:3080
  v_mfma_f32_16x16x32_bf16 v[68:71], v[92:95], v[140:143], v[68:71]
  s_waitcnt lgkmcnt(6)
  buffer_store_dwordx4 v[212:215], v4, s[20:23], s29 offen sc1
  v_mfma_f32_16x16x32_bf16 v[68:71], v[100:103], v[96:99], v[68:71]
  s_waitcnt lgkmcnt(5)
  ds_read_b64 v[112:113], v12 offset:2560
  ds_read_b64 v[114:115], v12 offset:2568
  v_mfma_f32_16x16x32_bf16 v[64:67], v[100:103], v[108:111], v[64:67]
  s_waitcnt lgkmcnt(5)
  ds_read_b64 v[124:125], v12 offset:2048
  ds_read_b64 v[126:127], v12 offset:2056
  v_mfma_f32_16x16x32_bf16 v[60:63], v[100:103], v[116:119], v[60:63]
  s_waitcnt lgkmcnt(6)
  ds_read_b64 v[128:129], v12 offset:3776
  ds_read_b64 v[130:131], v12 offset:3784
  v_mfma_f32_16x16x32_bf16 v[56:59], v[100:103], v[104:107], v[56:59]
  s_waitcnt lgkmcnt(6)
  ds_read_b128 v[132:135], v13 offset:11328
  ds_read_b128 v[136:139], v13 offset:9792
  v_mfma_f32_16x16x32_bf16 v[68:71], v[120:123], v[108:111], v[68:71]
  ds_read_b128 v[88:91], v13 offset:8256
  ds_read_b128 v[80:83], v13 offset:6720
  v_mfma_f32_16x16x32_bf16 v[64:67], v[120:123], v[116:119], v[64:67]
  ds_read_b64 v[84:85], v12 offset:3264
  ds_read_b64 v[86:87], v12 offset:3272
  v_mfma_f32_16x16x32_bf16 v[60:63], v[120:123], v[104:107], v[60:63]
  s_waitcnt lgkmcnt(10)
  ds_read_b128 v[92:95], v13 offset:5184
  ds_read_b64 v[140:141], v12 offset:2752
  v_mfma_f32_16x16x32_bf16 v[68:71], v[112:115], v[116:119], v[68:71]
  buffer_store_dwordx4 v[216:219], v4, s[20:23], s30 offen sc1
  v_mfma_f32_16x16x32_bf16 v[64:67], v[112:115], v[104:107], v[64:67]
  s_waitcnt lgkmcnt(10)
  ds_read_b64 v[142:143], v12 offset:2760
  ds_read_b128 v[96:99], v13 offset:3648
  v_mfma_f32_16x16x32_bf16 v[68:71], v[124:127], v[104:107], v[68:71]
  s_waitcnt lgkmcnt(9)
  ds_read_b64 v[100:101], v12 offset:2240
  ds_read_b64 v[102:103], v12 offset:2248
  v_mfma_f32_16x16x32_bf16 v[236:239], v[128:131], v[132:135], 0
  s_waitcnt lgkmcnt(10)
  v_mfma_f32_16x16x32_bf16 v[232:235], v[128:131], v[136:139], 0
  s_waitcnt lgkmcnt(9)
  ds_read_b128 v[108:111], v13 offset:2112
  v_mfma_f32_16x16x32_bf16 v[228:231], v[128:131], v[88:91], 0
  s_waitcnt lgkmcnt(9)
  ds_write_b128 v253, v[56:59] offset:0
  v_mfma_f32_16x16x32_bf16 v[224:227], v[128:131], v[80:83], 0
  s_waitcnt lgkmcnt(8)
  v_mfma_f32_16x16x32_bf16 v[236:239], v[84:87], v[136:139], v[236:239]
  v_mfma_f32_16x16x32_bf16 v[232:235], v[84:87], v[88:91], v[232:235]
  ds_write_b128 v253, v[60:63] offset:1024
  v_mfma_f32_16x16x32_bf16 v[228:231], v[84:87], v[80:83], v[228:231]
  s_waitcnt lgkmcnt(8)
  buffer_store_dwordx4 v[220:223], v4, s[20:23], s31 offen sc1
  v_mfma_f32_16x16x32_bf16 v[224:227], v[84:87], v[92:95], v[224:227]
  s_waitcnt lgkmcnt(6)
  v_mfma_f32_16x16x32_bf16 v[236:239], v[140:143], v[88:91], v[236:239]
  ds_write_b128 v253, v[64:67] offset:2048
  v_mfma_f32_16x16x32_bf16 v[232:235], v[140:143], v[80:83], v[232:235]
  v_mfma_f32_16x16x32_bf16 v[228:231], v[140:143], v[92:95], v[228:231]
  s_waitcnt lgkmcnt(6)
  ds_read_b64 v[120:121], v12 offset:1728
  ds_read_b64 v[122:123], v12 offset:1736
  v_mfma_f32_16x16x32_bf16 v[224:227], v[140:143], v[96:99], v[224:227]
  s_waitcnt lgkmcnt(6)
  ds_write_b128 v253, v[68:71] offset:3072
  v_mfma_f32_16x16x32_bf16 v[236:239], v[100:103], v[80:83], v[236:239]
  ds_read_b64_tr_b16 v[208:209], v248 offset:0
  v_mfma_f32_16x16x32_bf16 v[232:235], v[100:103], v[92:95], v[232:235]
  ds_read_b128 v[116:119], v13 offset:576
  ds_read_b64_tr_b16 v[210:211], v248 offset:1024
  v_mfma_f32_16x16x32_bf16 v[228:231], v[100:103], v[96:99], v[228:231]
  s_waitcnt lgkmcnt(9)
  ds_read_b64 v[112:113], v12 offset:1216
  ds_read_b64 v[114:115], v12 offset:1224
  v_mfma_f32_16x16x32_bf16 v[224:227], v[100:103], v[108:111], v[224:227]
  s_waitcnt lgkmcnt(6)
  ds_read_b64_tr_b16 v[212:213], v249 offset:0
  ds_read_b64_tr_b16 v[214:215], v249 offset:1024
  v_mfma_f32_16x16x32_bf16 v[236:239], v[120:123], v[92:95], v[236:239]
  ds_read_b64 v[104:105], v12 offset:704
  ds_read_b64 v[106:107], v12 offset:712
  v_mfma_f32_16x16x32_bf16 v[232:235], v[120:123], v[96:99], v[232:235]
  ds_read_b64 v[124:125], v12 offset:192
  ds_read_b64 v[126:127], v12 offset:200
  v_mfma_f32_16x16x32_bf16 v[228:231], v[120:123], v[108:111], v[228:231]
  s_waitcnt lgkmcnt(9)
  ds_read_b64 v[132:133], v12 offset:3712
  ds_read_b64 v[134:135], v12 offset:3720
  v_mfma_f32_16x16x32_bf16 v[224:227], v[120:123], v[116:119], v[224:227]
  s_waitcnt lgkmcnt(8)
  ds_read_b128 v[128:131], v13 offset:11136
  ds_read_b128 v[136:139], v13 offset:9600
  v_mfma_f32_16x16x32_bf16 v[236:239], v[112:115], v[96:99], v[236:239]
  s_waitcnt vmcnt(8)
  s_waitcnt lgkmcnt(8)
  s_barrier
  ds_read_b128 v[152:155], v16 offset:0
  ds_read_b128 v[156:159], v17 offset:0
  v_mfma_f32_16x16x32_bf16 v[232:235], v[112:115], v[108:111], v[232:235]
  ds_read_b128 v[84:87], v13 offset:8064
  ds_read_b128 v[88:91], v13 offset:6528
  ds_read_b128 v[160:163], v200 offset:0
  ds_read_b128 v[164:167], v201 offset:0
  v_mfma_f32_16x16x32_bf16 v[228:231], v[112:115], v[116:119], v[228:231]
  s_waitcnt lgkmcnt(12)
  ds_read_b64 v[140:141], v12 offset:3200
  ds_read_b64 v[142:143], v12 offset:3208
  ds_read_b128 v[168:171], v202 offset:0
  ds_read_b128 v[56:59], v250 offset:0
  v_mfma_f32_16x16x32_bf16 v[236:239], v[104:107], v[108:111], v[236:239]
  ds_read_b128 v[80:83], v13 offset:4992
  ds_read_b64 v[100:101], v12 offset:2688
  ds_read_b128 v[60:63], v250 offset:256
  ds_read_b128 v[64:67], v250 offset:4096
  v_mfma_f32_16x16x32_bf16 v[232:235], v[104:107], v[116:119], v[232:235]
  s_waitcnt lgkmcnt(14)
  ds_read_b64 v[102:103], v12 offset:2696
  ds_read_b128 v[92:95], v13 offset:3456
  ds_read_b128 v[68:71], v250 offset:4352
  ds_read_b64 v[184:185], v19 offset:0
  v_mfma_f32_16x16x32_bf16 v[236:239], v[124:127], v[116:119], v[236:239]
  ds_read_b64 v[120:121], v12 offset:2176
  ds_read_b64 v[122:123], v12 offset:2184
  ds_read_b64 v[186:187], v19 offset:2048
  ds_read_b64 v[188:189], v19 offset:4096
  v_mfma_f32_16x16x32_bf16 v[236:239], v[132:135], v[128:131], v[236:239]
  ds_read_b64 v[190:191], v19 offset:6144
  ds_read_b32 v192, v20 offset:0
  ds_read_b64 v[194:195], v21 offset:0
  ds_read_b64 v[196:197], v203 offset:0
  v_mfma_f32_16x16x32_bf16 v[232:235], v[132:135], v[136:139], v[232:235]
  s_waitcnt lgkmcnt(14)
  ds_read_b128 v[96:99], v13 offset:1920
  v_mfma_f32_16x16x32_bf16 v[228:231], v[132:135], v[84:87], v[228:231]
  ds_read_b64 v[112:113], v12 offset:1664
  ds_read_b64 v[114:115], v12 offset:1672
  v_lshlrev_b32 v172, 16, v152
  v_and_b32 v173, 0xffff0000, v152
  v_mfma_f32_16x16x32_bf16 v[224:227], v[132:135], v[88:91], v[224:227]
  v_lshlrev_b32 v174, 16, v153
  v_and_b32 v175, 0xffff0000, v153
  v_lshlrev_b32 v176, 16, v154
  v_and_b32 v177, 0xffff0000, v154
  v_mfma_f32_16x16x32_bf16 v[236:239], v[140:143], v[136:139], v[236:239]
  v_lshlrev_b32 v178, 16, v155
  v_and_b32 v179, 0xffff0000, v155
  v_fma_f32 v156, v172, v156, v164
  v_fma_f32 v157, v173, v157, v165
  v_mfma_f32_16x16x32_bf16 v[232:235], v[140:143], v[84:87], v[232:235]
  ds_read_b128 v[108:111], v13 offset:384
  v_fma_f32 v158, v174, v158, v166
  v_fma_f32 v159, v175, v159, v167
  v_fma_f32 v160, v176, v160, v168
  v_mfma_f32_16x16x32_bf16 v[228:231], v[140:143], v[88:91], v[228:231]
  ds_read_b64 v[104:105], v12 offset:1152
  ds_read_b64 v[106:107], v12 offset:1160
  v_fma_f32 v161, v177, v161, v169
  v_fma_f32 v162, v178, v162, v170
  v_mfma_f32_16x16x32_bf16 v[224:227], v[140:143], v[80:83], v[224:227]
  s_waitcnt lgkmcnt(14)
  s_waitcnt lgkmcnt(6)
  v_fma_f32 v163, v179, v163, v171
  v_add_f32 v56, v56, v64
  v_add_f32 v57, v57, v65
  v_mfma_f32_16x16x32_bf16 v[236:239], v[100:103], v[84:87], v[236:239]
  v_add_f32 v58, v58, v66
  v_add_f32 v59, v59, v67
  v_add_f32 v60, v60, v68
  v_add_f32 v61, v61, v69
  v_mfma_f32_16x16x32_bf16 v[232:235], v[100:103], v[88:91], v[232:235]
  ds_read_b64 v[116:117], v12 offset:640
  ds_read_b64 v[118:119], v12 offset:648
  v_add_f32 v62, v62, v70
  v_add_f32 v63, v63, v71
  v_mfma_f32_16x16x32_bf16 v[228:231], v[100:103], v[80:83], v[228:231]
  v_fmac_f32 v172, v156, v56
  v_fmac_f32 v173, v157, v57
  v_fmac_f32 v174, v158, v58
  v_fmac_f32 v175, v159, v59
  v_mfma_f32_16x16x32_bf16 v[224:227], v[100:103], v[92:95], v[224:227]
  ds_read_b64 v[124:125], v12 offset:128
  ds_read_b64 v[126:127], v12 offset:136
  v_fmac_f32 v176, v160, v60
  v_fmac_f32 v177, v161, v61
  v_mfma_f32_16x16x32_bf16 v[236:239], v[120:123], v[88:91], v[236:239]
  ds_read_b64 v[128:129], v14 offset:3648
  ds_read_b64 v[130:131], v14 offset:3656
  v_fmac_f32 v178, v162, v62
  v_fmac_f32 v179, v163, v63
  v_mfma_f32_16x16x32_bf16 v[232:235], v[120:123], v[80:83], v[232:235]
  ds_read_b128 v[132:135], v15 offset:9408
  ds_read_b128 v[136:139], v15 offset:7872
  v_cvt_pk_bf16_f32 v144, v172, v173
  v_cvt_pk_bf16_f32 v145, v174, v175
  v_mfma_f32_16x16x32_bf16 v[228:231], v[120:123], v[92:95], v[228:231]
  s_waitcnt lgkmcnt(13)
  ds_read_b64 v[140:141], v14 offset:3136
  ds_read_b64 v[142:143], v14 offset:3144
  v_cvt_pk_bf16_f32 v146, v176, v177
  v_cvt_pk_bf16_f32 v147, v178, v179
  v_mfma_f32_16x16x32_bf16 v[224:227], v[120:123], v[96:99], v[224:227]
  s_waitcnt lgkmcnt(13)
  buffer_store_dwordx4 v[144:147], v18, s[20:23], s13 offen sc1
  v_add_f32 v184, v184, v186
  v_add_f32 v188, v188, v190
  v_mfma_f32_16x16x32_bf16 v[236:239], v[112:115], v[80:83], v[236:239]
  ds_read_b128 v[84:87], v15 offset:6336
  ds_read_b64 v[100:101], v14 offset:2624
  v_add_f32 v185, v185, v187
  v_add_f32 v189, v189, v191
  v_mfma_f32_16x16x32_bf16 v[232:235], v[112:115], v[92:95], v[232:235]
  ds_read_b64 v[102:103], v14 offset:2632
  ds_read_b128 v[88:91], v15 offset:4800
  v_lshlrev_b32 v198, 16, v192
  v_and_b32 v199, 0xffff0000, v192
  v_mfma_f32_16x16x32_bf16 v[228:231], v[112:115], v[96:99], v[228:231]
  s_waitcnt lgkmcnt(14)
  ds_read_b64 v[120:121], v14 offset:2112
  ds_read_b64 v[122:123], v14 offset:2120
  v_add_f32 v184, v184, v188
  v_fma_f32 v194, v198, v194, v196
  v_mfma_f32_16x16x32_bf16 v[224:227], v[112:115], v[108:111], v[224:227]
  ds_read_b128 v[80:83], v15 offset:3264
  v_add_f32 v185, v185, v189
  v_fma_f32 v195, v199, v195, v197
  v_fmac_f32 v198, v194, v184
  v_mfma_f32_16x16x32_bf16 v[236:239], v[104:107], v[92:95], v[236:239]
  ds_read_b64 v[112:113], v14 offset:1600
  ds_read_b64 v[114:115], v14 offset:1608
  v_fmac_f32 v199, v195, v185
  v_cvt_pk_bf16_f32 v192, v198, v199
  v_mfma_f32_16x16x32_bf16 v[232:235], v[104:107], v[96:99], v[232:235]
  buffer_store_dword v192, v22, s[20:23], s14 offen sc1
  v_mfma_f32_16x16x32_bf16 v[228:231], v[104:107], v[108:111], v[228:231]
  s_waitcnt lgkmcnt(14)
  ds_read_b128 v[92:95], v15 offset:1728
  ds_read_b64 v[104:105], v14 offset:1088
  v_mfma_f32_16x16x32_bf16 v[236:239], v[116:119], v[96:99], v[236:239]
  ds_read_b64 v[106:107], v14 offset:1096
  ds_read_b128 v[96:99], v15 offset:192
  v_mfma_f32_16x16x32_bf16 v[232:235], v[116:119], v[108:111], v[232:235]
  s_waitcnt vmcnt(2)
  s_barrier
  ds_read_b64 v[116:117], v14 offset:576
  v_mfma_f32_16x16x32_bf16 v[236:239], v[124:127], v[108:111], v[236:239]
  s_waitcnt lgkmcnt(14)
  buffer_atomic_add v7, v5, s[20:23], 0 offen offset:256 sc1
  v_mfma_f32_16x16x32_bf16 v[76:79], v[128:131], v[132:135], 0
  ds_read_b64 v[118:119], v14 offset:584
  ds_read_b64 v[108:109], v14 offset:3584
  v_mfma_f32_16x16x32_bf16 v[72:75], v[128:131], v[136:139], 0
  ds_read_b64 v[110:111], v14 offset:3592
  ds_read_b128 v[124:127], v15 offset:9216
  v_mfma_f32_16x16x32_bf16 v[76:79], v[140:143], v[136:139], v[76:79]
  s_waitcnt lgkmcnt(14)
  buffer_store_dwordx4 v[208:211], v4, s[20:23], s6 offen sc1
  v_mfma_f32_16x16x32_bf16 v[72:75], v[140:143], v[84:87], v[72:75]
  ds_read_b128 v[132:135], v15 offset:7680
  ds_read_b64 v[128:129], v14 offset:3072
  v_mfma_f32_16x16x32_bf16 v[76:79], v[100:103], v[84:87], v[76:79]
  ds_read_b64 v[130:131], v14 offset:3080
  ds_read_b128 v[136:139], v15 offset:6144
  v_mfma_f32_16x16x32_bf16 v[72:75], v[100:103], v[88:91], v[72:75]
  s_waitcnt lgkmcnt(14)
  ds_read_b64 v[140:141], v14 offset:2560
  ds_read_b64 v[142:143], v14 offset:2568
  v_mfma_f32_16x16x32_bf16 v[76:79], v[120:123], v[88:91], v[76:79]
  ds_read_b128 v[84:87], v15 offset:4608
  ds_read_b64 v[100:101], v14 offset:2048
  v_mfma_f32_16x16x32_bf16 v[72:75], v[120:123], v[80:83], v[72:75]
  s_waitcnt lgkmcnt(14)
  ds_read_b64 v[102:103], v14 offset:2056
  ds_read_b128 v[88:91], v15 offset:3072
  v_mfma_f32_16x16x32_bf16 v[76:79], v[112:115], v[80:83], v[76:79]
  buffer_store_dwordx4 v[212:215], v4, s[20:23], s7 offen sc1
  v_mfma_f32_16x16x32_bf16 v[72:75], v[112:115], v[92:95], v[72:75]
  ds_read_b64 v[120:121], v14 offset:1536
  ds_read_b64 v[122:123], v14 offset:1544
  v_mfma_f32_16x16x32_bf16 v[76:79], v[104:107], v[92:95], v[76:79]
  s_waitcnt lgkmcnt(14)
  ds_read_b128 v[80:83], v15 offset:1536
  ds_read_b64 v[112:113], v14 offset:1024
  v_mfma_f32_16x16x32_bf16 v[72:75], v[104:107], v[96:99], v[72:75]
  ds_read_b64 v[114:115], v14 offset:1032
  ds_read_b128 v[92:95], v15 offset:0
  v_mfma_f32_16x16x32_bf16 v[76:79], v[116:119], v[96:99], v[76:79]
  s_waitcnt lgkmcnt(14)
  ds_read_b64 v[104:105], v14 offset:512
  ds_read_b64 v[106:107], v14 offset:520
  v_mfma_f32_16x16x32_bf16 v[76:79], v[108:111], v[124:127], v[76:79]
  ds_read_b64 v[96:97], v12 offset:3648
  ds_read_b64 v[98:99], v12 offset:3656
  v_mfma_f32_16x16x32_bf16 v[72:75], v[108:111], v[132:135], v[72:75]
  s_waitcnt lgkmcnt(14)
  ds_read_b128 v[116:119], v13 offset:10944
  ds_read_b128 v[124:127], v13 offset:9408
  v_mfma_f32_16x16x32_bf16 v[76:79], v[128:131], v[132:135], v[76:79]
  ds_read_b128 v[108:111], v13 offset:7872
  ds_read_b128 v[132:135], v13 offset:6336
  v_mfma_f32_16x16x32_bf16 v[72:75], v[128:131], v[136:139], v[72:75]
  ds_read_b64 v[128:129], v12 offset:3136
  ds_read_b64 v[130:131], v12 offset:3144
  v_mfma_f32_16x16x32_bf16 v[76:79], v[140:143], v[136:139], v[76:79]
  s_waitcnt lgkmcnt(14)
  v_mfma_f32_16x16x32_bf16 v[72:75], v[140:143], v[84:87], v[72:75]
  v_mfma_f32_16x16x32_bf16 v[76:79], v[100:103], v[84:87], v[76:79]
  ds_read_b128 v[136:139], v13 offset:4800
  v_mfma_f32_16x16x32_bf16 v[72:75], v[100:103], v[88:91], v[72:75]
  ds_read_b64 v[140:141], v12 offset:2624
  ds_read_b64 v[142:143], v12 offset:2632
  v_mfma_f32_16x16x32_bf16 v[76:79], v[120:123], v[88:91], v[76:79]
  s_waitcnt lgkmcnt(14)
  v_mfma_f32_16x16x32_bf16 v[72:75], v[120:123], v[80:83], v[72:75]
  v_mfma_f32_16x16x32_bf16 v[76:79], v[112:115], v[80:83], v[76:79]
  s_waitcnt lgkmcnt(13)
  ds_read_b128 v[84:87], v13 offset:3264
  v_mfma_f32_16x16x32_bf16 v[72:75], v[112:115], v[92:95], v[72:75]
  s_waitcnt lgkmcnt(12)
  ds_read_b64 v[100:101], v12 offset:2112
  ds_read_b64 v[102:103], v12 offset:2120
  v_mfma_f32_16x16x32_bf16 v[76:79], v[104:107], v[92:95], v[76:79]
  s_waitcnt lgkmcnt(11)
  v_mfma_f32_16x16x32_bf16 v[236:239], v[96:99], v[116:119], v[236:239]
  s_waitcnt lgkmcnt(10)
  v_mfma_f32_16x16x32_bf16 v[232:235], v[96:99], v[124:127], v[232:235]
  s_waitcnt lgkmcnt(9)
  ds_write_b128 v25, v[72:75] offset:24576
  v_mfma_f32_16x16x32_bf16 v[228:231], v[96:99], v[108:111], v[228:231]
  s_waitcnt lgkmcnt(9)
  v_mfma_f32_16x16x32_bf16 v[224:227], v[96:99], v[132:135], v[224:227]
  s_waitcnt lgkmcnt(7)
  v_mfma_f32_16x16x32_bf16 v[236:239], v[128:131], v[124:127], v[236:239]
  ds_write_b128 v25, v[76:79] offset:25600
  v_mfma_f32_16x16x32_bf16 v[232:235], v[128:131], v[108:111], v[232:235]
  v_mfma_f32_16x16x32_bf16 v[228:231], v[128:131], v[132:135], v[228:231]
  s_waitcnt lgkmcnt(7)
  v_mfma_f32_16x16x32_bf16 v[224:227], v[128:131], v[136:139], v[224:227]
  s_waitcnt lgkmcnt(5)
  ds_read_b128 v[88:91], v13 offset:1728
  ds_read_b64 v[120:121], v12 offset:1600
  v_mfma_f32_16x16x32_bf16 v[236:239], v[140:143], v[108:111], v[236:239]
  ds_read_b64 v[122:123], v12 offset:1608
  ds_read_b128 v[80:83], v13 offset:192
  v_mfma_f32_16x16x32_bf16 v[232:235], v[140:143], v[132:135], v[232:235]
  ds_read_b64 v[112:113], v12 offset:1088
  ds_read_b64 v[114:115], v12 offset:1096
  v_mfma_f32_16x16x32_bf16 v[228:231], v[140:143], v[136:139], v[228:231]
  s_waitcnt lgkmcnt(10)
  ds_read_b64 v[92:93], v12 offset:576
  ds_read_b64 v[94:95], v12 offset:584
  v_mfma_f32_16x16x32_bf16 v[224:227], v[140:143], v[84:87], v[224:227]
  s_waitcnt lgkmcnt(10)
  ds_read_b64 v[104:105], v12 offset:64
  ds_read_b64 v[106:107], v12 offset:72
  v_mfma_f32_16x16x32_bf16 v[236:239], v[100:103], v[132:135], v[236:239]
  ds_read_b64 v[116:117], v12 offset:3584
  ds_read_b64 v[118:119], v12 offset:3592
  v_mfma_f32_16x16x32_bf16 v[232:235], v[100:103], v[136:139], v[232:235]
  ds_read_b128 v[96:99], v13 offset:10752
  ds_read_b128 v[124:127], v13 offset:9216
  v_mfma_f32_16x16x32_bf16 v[228:231], v[100:103], v[84:87], v[228:231]
  s_waitcnt lgkmcnt(13)
  ds_read_b128 v[128:131], v13 offset:7680
  v_mfma_f32_16x16x32_bf16 v[224:227], v[100:103], v[88:91], v[224:227]
  s_waitcnt lgkmcnt(12)
  ds_read_b128 v[108:111], v13 offset:6144
  v_mfma_f32_16x16x32_bf16 v[236:239], v[120:123], v[136:139], v[236:239]
  s_waitcnt vmcnt(0)
  s_barrier
  ds_read_b64 v[140:141], v12 offset:3072
  v_mfma_f32_16x16x32_bf16 v[232:235], v[120:123], v[84:87], v[232:235]
  buffer_atomic_add v7, v5, s[20:23], 0 offen offset:512 sc1
  v_mfma_f32_16x16x32_bf16 v[228:231], v[120:123], v[88:91], v[228:231]
  s_waitcnt lgkmcnt(13)
  s_add_u32 s13, s13, 1314816
  ds_read_b64 v[142:143], v12 offset:3080
  v_mfma_f32_16x16x32_bf16 v[224:227], v[120:123], v[80:83], v[224:227]
  s_waitcnt lgkmcnt(12)
  s_add_u32 s14, s14, 1314816
  ds_read_b128 v[132:135], v13 offset:4608
  v_mfma_f32_16x16x32_bf16 v[236:239], v[112:115], v[84:87], v[236:239]
  ds_read_b64 v[100:101], v12 offset:2560
  ds_read_b64 v[102:103], v12 offset:2568
  v_mfma_f32_16x16x32_bf16 v[232:235], v[112:115], v[88:91], v[232:235]
  ds_read_b128 v[152:155], v16 offset:6144
  ds_read_b128 v[156:159], v17 offset:8192
  v_mfma_f32_16x16x32_bf16 v[228:231], v[112:115], v[80:83], v[228:231]
  s_waitcnt lgkmcnt(14)
  buffer_load_dword v8, v6, s[20:23], 0 offen offset:256 sc1
  v_mfma_f32_16x16x32_bf16 v[236:239], v[92:95], v[88:91], v[236:239]
  ds_read_b128 v[136:139], v13 offset:3072
  ds_read_b128 v[160:163], v200 offset:8192
  v_mfma_f32_16x16x32_bf16 v[232:235], v[92:95], v[80:83], v[232:235]
  s_waitcnt lgkmcnt(14)
  ds_read_b64 v[120:121], v12 offset:2048
  ds_read_b64 v[122:123], v12 offset:2056
  v_mfma_f32_16x16x32_bf16 v[236:239], v[104:107], v[80:83], v[236:239]
  s_waitcnt lgkmcnt(14)
  ds_read_b128 v[164:167], v201 offset:8192
  ds_read_b128 v[168:171], v202 offset:8192
  v_mfma_f32_16x16x32_bf16 v[236:239], v[116:119], v[96:99], v[236:239]
  s_waitcnt lgkmcnt(14)
  ds_read_b64 v[184:185], v19 offset:8192
  ds_read_b64 v[186:187], v19 offset:10240
  v_mfma_f32_16x16x32_bf16 v[232:235], v[116:119], v[124:127], v[232:235]
  ds_read_b128 v[84:87], v13 offset:1536
  ds_read_b64 v[188:189], v19 offset:12288
  v_mfma_f32_16x16x32_bf16 v[228:231], v[116:119], v[128:131], v[228:231]
  s_waitcnt lgkmcnt(14)
  ds_read_b64 v[112:113], v12 offset:1536
  ds_read_b64 v[114:115], v12 offset:1544
  v_mfma_f32_16x16x32_bf16 v[224:227], v[116:119], v[108:111], v[224:227]
  ds_read_b64 v[190:191], v19 offset:14336
  ds_read_b32 v192, v20 offset:6144
  v_mfma_f32_16x16x32_bf16 v[236:239], v[140:143], v[124:127], v[236:239]
  ds_read_b64 v[194:195], v21 offset:8192
  ds_read_b64 v[196:197], v203 offset:8192
  v_mfma_f32_16x16x32_bf16 v[232:235], v[140:143], v[128:131], v[232:235]
  s_waitcnt lgkmcnt(10)
  ds_read_b128 v[88:91], v13 offset:0
  v_lshlrev_b32 v172, 16, v152
  v_mfma_f32_16x16x32_bf16 v[228:231], v[140:143], v[108:111], v[228:231]
  ds_read_b64 v[92:93], v12 offset:1024
  ds_read_b64 v[94:95], v12 offset:1032
  v_mfma_f32_16x16x32_bf16 v[224:227], v[140:143], v[132:135], v[224:227]
  v_and_b32 v173, 0xffff0000, v152
  v_lshlrev_b32 v174, 16, v153
  v_mfma_f32_16x16x32_bf16 v[236:239], v[100:103], v[128:131], v[236:239]
  v_and_b32 v175, 0xffff0000, v153
  v_lshlrev_b32 v176, 16, v154
  v_mfma_f32_16x16x32_bf16 v[232:235], v[100:103], v[108:111], v[232:235]
  ds_read_b64 v[80:81], v12 offset:512
  ds_read_b64 v[82:83], v12 offset:520
  v_mfma_f32_16x16x32_bf16 v[228:231], v[100:103], v[132:135], v[228:231]
  v_and_b32 v177, 0xffff0000, v154
  v_lshlrev_b32 v178, 16, v155
  v_mfma_f32_16x16x32_bf16 v[224:227], v[100:103], v[136:139], v[224:227]
  ds_read_b64 v[104:105], v12 offset:0
  ds_read_b64 v[106:107], v12 offset:8
  v_mfma_f32_16x16x32_bf16 v[236:239], v[120:123], v[108:111], v[236:239]
  v_and_b32 v179, 0xffff0000, v155
  v_fma_f32 v156, v172, v156, v164
  v_mfma_f32_16x16x32_bf16 v[232:235], v[120:123], v[132:135], v[232:235]
  v_fma_f32 v157, v173, v157, v165
  v_fma_f32 v158, v174, v158, v166
  v_mfma_f32_16x16x32_bf16 v[228:231], v[120:123], v[136:139], v[228:231]
  s_waitcnt lgkmcnt(14)
  v_fma_f32 v159, v175, v159, v167
  v_fma_f32 v160, v176, v160, v168
  v_mfma_f32_16x16x32_bf16 v[224:227], v[120:123], v[84:87], v[224:227]
  s_waitcnt lgkmcnt(11)
  v_fma_f32 v161, v177, v161, v169
  v_fma_f32 v162, v178, v162, v170
  v_mfma_f32_16x16x32_bf16 v[236:239], v[112:115], v[132:135], v[236:239]
  s_waitcnt lgkmcnt(7)
  v_fma_f32 v163, v179, v163, v171
  v_add_f32 v184, v184, v186
  v_mfma_f32_16x16x32_bf16 v[232:235], v[112:115], v[136:139], v[232:235]
  v_add_f32 v188, v188, v190
  v_add_f32 v185, v185, v187
  v_mfma_f32_16x16x32_bf16 v[228:231], v[112:115], v[84:87], v[228:231]
  s_waitcnt lgkmcnt(6)
  v_add_f32 v189, v189, v191
  v_lshlrev_b32 v198, 16, v192
  v_mfma_f32_16x16x32_bf16 v[224:227], v[112:115], v[88:91], v[224:227]
  s_waitcnt lgkmcnt(4)
  v_and_b32 v199, 0xffff0000, v192
  v_add_f32 v184, v184, v188
  v_mfma_f32_16x16x32_bf16 v[236:239], v[92:95], v[136:139], v[236:239]
  v_fma_f32 v194, v198, v194, v196
  v_add_f32 v185, v185, v189
  v_mfma_f32_16x16x32_bf16 v[232:235], v[92:95], v[84:87], v[232:235]
  v_fma_f32 v195, v199, v195, v197
  v_fmac_f32 v198, v194, v184
  v_mfma_f32_16x16x32_bf16 v[228:231], v[92:95], v[88:91], v[228:231]
  s_waitcnt lgkmcnt(2)
  v_fmac_f32 v199, v195, v185
  v_cvt_pk_bf16_f32 v192, v198, v199
  v_mfma_f32_16x16x32_bf16 v[236:239], v[80:83], v[84:87], v[236:239]
  buffer_store_dword v192, v22, s[20:23], s14 offen sc1
  v_mfma_f32_16x16x32_bf16 v[232:235], v[80:83], v[88:91], v[232:235]
  s_waitcnt lgkmcnt(0)
  v_mfma_f32_16x16x32_bf16 v[236:239], v[104:107], v[88:91], v[236:239]
j_12:
  s_waitcnt vmcnt(1)
  v_cmp_ne_u32 vcc, 16, v8
  s_cbranch_vccnz slow_13
back_14:
  s_bitcmp1_b32 s3, 0
  s_cbranch_scc1 o_15
  s_nop 0
  ds_write_b128 v23, v[232:235]
  s_nop 0
  ds_write_b128 v23, v[236:239] offset:1024
  s_waitcnt lgkmcnt(0)
  s_barrier
  ds_read_b128 v[232:235], v24
  ds_read_b128 v[236:239], v24 offset:1024
  s_branch j_16
o_15:
  ds_write_b128 v23, v[224:227]
  ds_write_b128 v23, v[228:231] offset:1024
  s_waitcnt lgkmcnt(0)
  s_barrier
  ds_read_b128 v[224:227], v24
  ds_read_b128 v[228:231], v24 offset:1024
j_16:
  global_load_dwordx4 a[0:3], v53, s[20:21] offset:-4096 sc1
  global_load_dwordx4 a[4:7], v53, s[20:21] offset:-3072 sc1
  global_load_dwordx4 a[8:11], v53, s[20:21] offset:-2048 sc1
  s_waitcnt lgkmcnt(0)
  v_pk_add_f32 v[224:225], v[224:225], v[232:233]
  v_pk_add_f32 v[226:227], v[226:227], v[234:235]
  v_pk_add_f32 v[228:229], v[228:229], v[236:237]
  v_pk_add_f32 v[230:231], v[230:231], v[238:239]
  s_nop 0
  v_permlane16_swap_b32 v224, v228
  v_permlane16_swap_b32 v225, v229
  v_permlane16_swap_b32 v226, v230
  v_permlane16_swap_b32 v227, v231
  v_pk_fma_f32 v[172:173], v[156:157], v[224:225], v[172:173]
  v_pk_fma_f32 v[174:175], v[158:159], v[226:227], v[174:175]
  v_pk_fma_f32 v[176:177], v[160:161], v[228:229], v[176:177]
  v_pk_fma_f32 v[178:179], v[162:163], v[230:231], v[178:179]
  v_cvt_pk_bf16_f32 v144, v172, v173
  v_cvt_pk_bf16_f32 v145, v174, v175
  v_cvt_pk_bf16_f32 v146, v176, v177
  v_cvt_pk_bf16_f32 v147, v178, v179
  buffer_store_dwordx4 v[144:147], v18, s[20:23], s13 offen sc1
  v_add_u32 v0, s16, v4
  v_add_u32 v2, s68, v4
  global_load_dwordx4 a[12:15], v53, s[20:21] offset:-1024 sc1
  global_load_dwordx4 a[16:19], v53, s[20:21] offset:0 sc1
  global_load_dwordx4 a[20:23], v53, s[20:21] offset:1024 sc1
  global_load_dwordx4 a[24:27], v53, s[20:21] offset:2048 sc1
  global_load_dwordx4 a[28:31], v53, s[20:21] offset:3072 sc1
  v_add_u32 v53, 8192, v53
  global_load_dwordx4 a[32:35], v53, s[20:21] offset:-4096 sc1
  global_load_dwordx4 a[36:39], v53, s[20:21] offset:-3072 sc1
  global_load_dwordx4 a[40:43], v53, s[20:21] offset:-2048 sc1
  global_load_dwordx4 a[44:47], v53, s[20:21] offset:-1024 sc1
  global_load_dwordx4 a[48:51], v53, s[20:21] offset:0 sc1
  buffer_load_dword v8, v6, s[20:23], 0 offen offset:512 sc1
  global_load_dwordx4 a[52:55], v53, s[20:21] offset:1024 sc1
  global_load_dwordx4 a[56:59], v53, s[20:21] offset:2048 sc1
  global_load_dwordx4 a[60:63], v53, s[20:21] offset:3072 sc1
  v_add_u32 v53, 8192, v53
  global_load_dwordx4 a[64:67], v53, s[20:21] offset:-4096 sc1
  s_waitcnt vmcnt(4)
  v_cmp_ne_u32 vcc, 16, v8
  s_cbranch_vccnz slow_17
back_18:
  s_barrier
  s_add_u32 m0, s17, 0
  s_nop 0
  global_load_lds_dwordx4 v0, s[20:21] offset:0 sc1
  global_load_lds_dwordx4 v0, s[20:21] offset:1024 sc1
  global_load_lds_dwordx4 v0, s[20:21] offset:2048 sc1
  global_load_lds_dwordx4 v0, s[20:21] offset:3072 sc1
  v_add_u32 v0, 4096, v0
  s_add_u32 m0, s17, 4096
  s_nop 0
  global_load_lds_dwordx4 v0, s[20:21] offset:0 sc1
  global_load_lds_dwordx4 v0, s[20:21] offset:1024 sc1
  global_load_lds_dwordx4 v0, s[20:21] offset:2048 sc1
  global_load_lds_dwordx4 v0, s[20:21] offset:3072 sc1
  v_add_u32 v0, 4096, v0
  s_add_u32 m0, s17, 8192
  s_nop 0
  global_load_lds_dwordx4 v0, s[20:21] offset:0 sc1
  global_load_lds_dwordx4 v0, s[20:21] offset:1024 sc1
  v_add_u32 v0, 32896, v0
  s_add_u32 m0, s17, 40960
  s_nop 0
  global_load_lds_dwordx4 v0, s[20:21] offset:0 sc1
  global_load_lds_dwordx4 v0, s[20:21] offset:1024 sc1
  global_load_lds_dwordx4 v0, s[20:21] offset:2048 sc1
  global_load_lds_dwordx4 v0, s[20:21] offset:3072 sc1
  s_waitcnt vmcnt(12)
  ds_read_b64_tr_b16 v[136:137], v26 offset:0
  ds_read_b64_tr_b16 v[138:139], v26 offset:1024
  ds_read_b64_tr_b16 v[140:141], v27 offset:0
  ds_read_b64_tr_b16 v[142:143], v27 offset:1024
  s_waitcnt vmcnt(10)
  ds_read_b64_tr_b16 v[144:145], v26 offset:2048
  ds_read_b64_tr_b16 v[146:147], v26 offset:3072
  ds_read_b64_tr_b16 v[148:149], v27 offset:2048
  ds_read_b64_tr_b16 v[150:151], v27 offset:3072
  s_waitcnt lgkmcnt(6)
  v_mfma_f32_16x16x32_bf16 v[72:75], v[44:47], v[136:139], 0
  s_waitcnt vmcnt(8)
  s_add_u32 m0, s17, 45056
  v_add_u32 v0, 4096, v0
  global_load_lds_dwordx4 v0, s[20:21] offset:0 sc1
  v_mfma_f32_16x16x32_bf16 v[80:83], v[136:139], v[136:139], 0
  ds_read_b64_tr_b16 v[152:153], v26 offset:4096
  ds_read_b64_tr_b16 v[154:155], v26 offset:5120
  v_mfma_f32_16x16x32_bf16 v[88:91], a[0:3], v[136:139], 0
  ds_read_b64_tr_b16 v[156:157], v27 offset:4096
  ds_read_b64_tr_b16 v[158:159], v27 offset:5120
  v_mfma_f32_16x16x32_bf16 v[92:95], a[4:7], v[136:139], 0
  global_load_lds_dwordx4 v0, s[20:21] offset:1024 sc1
  v_mfma_f32_16x16x32_bf16 v[96:99], a[8:11], v[136:139], 0
  s_waitcnt lgkmcnt(8)
  v_mfma_f32_16x16x32_bf16 v[76:79], v[44:47], v[140:143], 0
  v_mfma_f32_16x16x32_bf16 v[84:87], v[140:143], v[140:143], 0
  global_load_lds_dwordx4 v0, s[20:21] offset:2048 sc1
  v_mfma_f32_16x16x32_bf16 v[100:103], a[0:3], v[140:143], 0
  v_mfma_f32_16x16x32_bf16 v[104:107], a[4:7], v[140:143], 0
  v_mfma_f32_16x16x32_bf16 v[108:111], a[8:11], v[140:143], 0
  s_waitcnt lgkmcnt(6)
  global_load_lds_dwordx4 v0, s[20:21] offset:3072 sc1
  v_mfma_f32_16x16x32_bf16 v[72:75], v[44:47], v[144:147], v[72:75]
  s_waitcnt vmcnt(10)
  ds_read_b64_tr_b16 v[136:137], v26 offset:6144
  ds_read_b64_tr_b16 v[138:139], v26 offset:7168
  v_mfma_f32_16x16x32_bf16 v[80:83], v[144:147], v[144:147], v[80:83]
  ds_read_b64_tr_b16 v[140:141], v27 offset:6144
  ds_read_b64_tr_b16 v[142:143], v27 offset:7168
  v_mfma_f32_16x16x32_bf16 v[88:91], a[12:15], v[144:147], v[88:91]
  s_add_u32 m0, s17, 49152
  v_add_u32 v0, 4096, v0
  global_load_lds_dwordx4 v0, s[20:21] offset:0 sc1
  v_mfma_f32_16x16x32_bf16 v[92:95], a[16:19], v[144:147], v[92:95]
  v_mfma_f32_16x16x32_bf16 v[96:99], a[20:23], v[144:147], v[96:99]
  s_waitcnt lgkmcnt(8)
  v_mfma_f32_16x16x32_bf16 v[76:79], v[44:47], v[148:151], v[76:79]
  global_load_lds_dwordx4 v0, s[20:21] offset:1024 sc1
  v_mfma_f32_16x16x32_bf16 v[84:87], v[148:151], v[148:151], v[84:87]
  v_mfma_f32_16x16x32_bf16 v[100:103], a[12:15], v[148:151], v[100:103]
  v_mfma_f32_16x16x32_bf16 v[104:107], a[16:19], v[148:151], v[104:107]
  buffer_load_dwordx4 v[56:59], v251, s[20:23], s36 offen offset:0 sc1
  v_mfma_f32_16x16x32_bf16 v[108:111], a[20:23], v[148:151], v[108:111]
  s_waitcnt lgkmcnt(6)
  v_mfma_f32_16x16x32_bf16 v[72:75], v[44:47], v[152:155], v[72:75]
  s_waitcnt vmcnt(11)
  ds_read_b64_tr_b16 v[144:145], v26 offset:8192
  ds_read_b64_tr_b16 v[146:147], v26 offset:9216
  v_mfma_f32_16x16x32_bf16 v[80:83], v[152:155], v[152:155], v[80:83]
  buffer_load_dwordx4 v[176:179], v252, s[20:23], s36 offen offset:1024 sc1
  v_mfma_f32_16x16x32_bf16 v[88:91], a[24:27], v[152:155], v[88:91]
  ds_read_b64_tr_b16 v[148:149], v27 offset:8192
  ds_read_b64_tr_b16 v[150:151], v27 offset:9216
  v_mfma_f32_16x16x32_bf16 v[92:95], a[28:31], v[152:155], v[92:95]
  v_mfma_f32_16x16x32_bf16 v[96:99], a[32:35], v[152:155], v[96:99]
  s_waitcnt lgkmcnt(8)
  buffer_load_dwordx4 v[60:63], v251, s[20:23], s36 offen offset:1280 sc1
  v_mfma_f32_16x16x32_bf16 v[76:79], v[44:47], v[156:159], v[76:79]
  v_mfma_f32_16x16x32_bf16 v[84:87], v[156:159], v[156:159], v[84:87]
  v_mfma_f32_16x16x32_bf16 v[100:103], a[24:27], v[156:159], v[100:103]
  buffer_load_dwordx4 v[180:183], v252, s[20:23], s36 offen offset:2304 sc1
  v_mfma_f32_16x16x32_bf16 v[104:107], a[28:31], v[156:159], v[104:107]
  v_mfma_f32_16x16x32_bf16 v[108:111], a[32:35], v[156:159], v[108:111]
  s_waitcnt lgkmcnt(6)
  v_mfma_f32_16x16x32_bf16 v[72:75], v[44:47], v[136:139], v[72:75]
  s_waitcnt vmcnt(12)
  buffer_load_dwordx4 v[64:67], v251, s[20:23], s36 offen offset:2560 sc1
  v_mfma_f32_16x16x32_bf16 v[80:83], v[136:139], v[136:139], v[80:83]
  ds_read_b64_tr_b16 v[152:153], v26 offset:40960
  ds_read_b64_tr_b16 v[154:155], v26 offset:41984
  v_mfma_f32_16x16x32_bf16 v[88:91], a[36:39], v[136:139], v[88:91]
  ds_read_b64_tr_b16 v[156:157], v27 offset:40960
  ds_read_b64_tr_b16 v[158:159], v27 offset:41984
  v_mfma_f32_16x16x32_bf16 v[92:95], a[40:43], v[136:139], v[92:95]
  buffer_load_dwordx4 v[184:187], v252, s[20:23], s36 offen offset:3584 sc1
  v_mfma_f32_16x16x32_bf16 v[96:99], a[44:47], v[136:139], v[96:99]
  s_waitcnt lgkmcnt(8)
  v_mfma_f32_16x16x32_bf16 v[76:79], v[44:47], v[140:143], v[76:79]
  v_mfma_f32_16x16x32_bf16 v[84:87], v[140:143], v[140:143], v[84:87]
  global_load_dwordx4 a[68:71], v53, s[20:21] offset:-3072 sc1
  v_mfma_f32_16x16x32_bf16 v[100:103], a[36:39], v[140:143], v[100:103]
  v_mfma_f32_16x16x32_bf16 v[104:107], a[40:43], v[140:143], v[104:107]
  v_mfma_f32_16x16x32_bf16 v[108:111], a[44:47], v[140:143], v[108:111]
  s_waitcnt lgkmcnt(6)
  global_load_dwordx4 a[72:75], v53, s[20:21] offset:-2048 sc1
  v_mfma_f32_16x16x32_bf16 v[72:75], v[44:47], v[144:147], v[72:75]
  s_waitcnt vmcnt(14)
  ds_read_b64_tr_b16 v[136:137], v26 offset:43008
  ds_read_b64_tr_b16 v[138:139], v26 offset:44032
  v_mfma_f32_16x16x32_bf16 v[80:83], v[144:147], v[144:147], v[80:83]
  ds_read_b64_tr_b16 v[140:141], v27 offset:43008
  ds_read_b64_tr_b16 v[142:143], v27 offset:44032
  v_mfma_f32_16x16x32_bf16 v[88:91], a[48:51], v[144:147], v[88:91]
  global_load_dwordx4 a[76:79], v53, s[20:21] offset:-1024 sc1
  v_mfma_f32_16x16x32_bf16 v[92:95], a[52:55], v[144:147], v[92:95]
  v_mfma_f32_16x16x32_bf16 v[96:99], a[56:59], v[144:147], v[96:99]
  s_waitcnt lgkmcnt(8)
  v_mfma_f32_16x16x32_bf16 v[76:79], v[44:47], v[148:151], v[76:79]
  global_load_dwordx4 a[80:83], v53, s[20:21] offset:0 sc1
  v_mfma_f32_16x16x32_bf16 v[84:87], v[148:151], v[148:151], v[84:87]
  v_mfma_f32_16x16x32_bf16 v[100:103], a[48:51], v[148:151], v[100:103]
  v_mfma_f32_16x16x32_bf16 v[104:107], a[52:55], v[148:151], v[104:107]
  global_load_dwordx4 a[84:87], v53, s[20:21] offset:1024 sc1
  v_mfma_f32_16x16x32_bf16 v[108:111], a[56:59], v[148:151], v[108:111]
  s_waitcnt lgkmcnt(6)
  v_mfma_f32_16x16x32_bf16 v[160:163], v[44:47], v[152:155], 0
  s_waitcnt vmcnt(15)
  ds_read_b64_tr_b16 v[144:145], v26 offset:45056
  ds_read_b64_tr_b16 v[146:147], v26 offset:46080
  v_mfma_f32_16x16x32_bf16 v[168:171], v[152:155], v[152:155], 0
  global_load_dwordx4 a[88:91], v53, s[20:21] offset:2048 sc1
  ds_read_b64_tr_b16 v[148:149], v27 offset:45056
  v_mfma_f32_16x16x32_bf16 v[112:115], a[0:3], v[152:155], 0
  ds_read_b64_tr_b16 v[150:151], v27 offset:46080
  v_mfma_f32_16x16x32_bf16 v[116:119], a[4:7], v[152:155], 0
  v_mfma_f32_16x16x32_bf16 v[120:123], a[8:11], v[152:155], 0
  s_waitcnt lgkmcnt(8)
  global_load_dwordx4 a[92:95], v53, s[20:21] offset:3072 sc1
  v_mfma_f32_16x16x32_bf16 v[164:167], v[44:47], v[156:159], 0
  v_mfma_f32_16x16x32_bf16 v[172:175], v[156:159], v[156:159], 0
  v_mfma_f32_16x16x32_bf16 v[124:127], a[0:3], v[156:159], 0
  v_add_u32 v53, 8192, v53
  global_load_dwordx4 a[96:99], v53, s[20:21] offset:-4096 sc1
  v_mfma_f32_16x16x32_bf16 v[128:131], a[4:7], v[156:159], 0
  v_mfma_f32_16x16x32_bf16 v[132:135], a[8:11], v[156:159], 0
  s_waitcnt lgkmcnt(6)
  v_mfma_f32_16x16x32_bf16 v[160:163], v[44:47], v[136:139], v[160:163]
  s_waitcnt vmcnt(16)
  global_load_dwordx4 a[100:103], v53, s[20:21] offset:-3072 sc1
  ds_read_b64_tr_b16 v[152:153], v26 offset:47104
  v_mfma_f32_16x16x32_bf16 v[168:171], v[136:139], v[136:139], v[168:171]
  ds_read_b64_tr_b16 v[154:155], v26 offset:48128
  ds_read_b64_tr_b16 v[156:157], v27 offset:47104
  v_mfma_f32_16x16x32_bf16 v[112:115], a[12:15], v[136:139], v[112:115]
  ds_read_b64_tr_b16 v[158:159], v27 offset:48128
  v_mfma_f32_16x16x32_bf16 v[116:119], a[16:19], v[136:139], v[116:119]
  global_load_dwordx4 a[104:107], v53, s[20:21] offset:-2048 sc1
  v_mfma_f32_16x16x32_bf16 v[120:123], a[20:23], v[136:139], v[120:123]
  s_waitcnt lgkmcnt(8)
  v_mfma_f32_16x16x32_bf16 v[164:167], v[44:47], v[140:143], v[164:167]
  v_mfma_f32_16x16x32_bf16 v[172:175], v[140:143], v[140:143], v[172:175]
  global_load_dwordx4 a[108:111], v53, s[20:21] offset:-1024 sc1
  v_mfma_f32_16x16x32_bf16 v[124:127], a[12:15], v[140:143], v[124:127]
  v_mfma_f32_16x16x32_bf16 v[128:131], a[16:19], v[140:143], v[128:131]
  v_mfma_f32_16x16x32_bf16 v[132:135], a[20:23], v[140:143], v[132:135]
  s_waitcnt lgkmcnt(6)
  global_load_dwordx4 a[112:115], v53, s[20:21] offset:0 sc1
  v_mfma_f32_16x16x32_bf16 v[160:163], v[44:47], v[144:147], v[160:163]
  s_waitcnt vmcnt(18)
  ds_read_b64_tr_b16 v[136:137], v26 offset:49152
  ds_read_b64_tr_b16 v[138:139], v26 offset:50176
  v_mfma_f32_16x16x32_bf16 v[168:171], v[144:147], v[144:147], v[168:171]
  ds_read_b64_tr_b16 v[140:141], v27 offset:49152
  ds_read_b64_tr_b16 v[142:143], v27 offset:50176
  v_mfma_f32_16x16x32_bf16 v[112:115], a[24:27], v[144:147], v[112:115]
  global_load_dwordx4 a[116:119], v53, s[20:21] offset:1024 sc1
  v_mfma_f32_16x16x32_bf16 v[116:119], a[28:31], v[144:147], v[116:119]
  v_mfma_f32_16x16x32_bf16 v[120:123], a[32:35], v[144:147], v[120:123]
  s_waitcnt lgkmcnt(8)
  v_mfma_f32_16x16x32_bf16 v[164:167], v[44:47], v[148:151], v[164:167]
  global_load_dwordx4 a[120:123], v53, s[20:21] offset:2048 sc1
  v_mfma_f32_16x16x32_bf16 v[172:175], v[148:151], v[148:151], v[172:175]
  v_mfma_f32_16x16x32_bf16 v[124:127], a[24:27], v[148:151], v[124:127]
  v_mfma_f32_16x16x32_bf16 v[128:131], a[28:31], v[148:151], v[128:131]
  global_load_dwordx4 a[124:127], v53, s[20:21] offset:3072 sc1
  v_mfma_f32_16x16x32_bf16 v[132:135], a[32:35], v[148:151], v[132:135]
  s_waitcnt lgkmcnt(6)
  v_mfma_f32_16x16x32_bf16 v[160:163], v[44:47], v[152:155], v[160:163]
  s_barrier
  ds_read_b64_tr_b16 v[144:145], v28 offset:0
  ds_read_b64_tr_b16 v[146:147], v28 offset:1024
  v_mfma_f32_16x16x32_bf16 v[168:171], v[152:155], v[152:155], v[168:171]
  v_add_u32 v53, 8192, v53
  global_load_dwordx4 a[128:131], v53, s[20:21] offset:-4096 sc1
  v_mfma_f32_16x16x32_bf16 v[112:115], a[36:39], v[152:155], v[112:115]
  s_waitcnt vmcnt(16)
  buffer_atomic_add v7, v5, s[20:23], 0 offen offset:768 sc1
  v_mfma_f32_16x16x32_bf16 v[116:119], a[40:43], v[152:155], v[116:119]
  ds_read_b64_tr_b16 v[148:149], v29 offset:0
  ds_read_b64_tr_b16 v[150:151], v29 offset:1024
  v_mfma_f32_16x16x32_bf16 v[120:123], a[44:47], v[152:155], v[120:123]
  s_waitcnt lgkmcnt(8)
  global_load_dwordx4 a[132:135], v53, s[20:21] offset:-3072 sc1
  v_add_f32 v56, v56, v176
  v_mfma_f32_16x16x32_bf16 v[164:167], v[44:47], v[156:159], v[164:167]
  v_add_f32 v57, v57, v177
  v_add_f32 v58, v58, v178
  v_mfma_f32_16x16x32_bf16 v[172:175], v[156:159], v[156:159], v[172:175]
  v_add_f32 v59, v59, v179
  v_add_f32 v60, v60, v180
  v_mfma_f32_16x16x32_bf16 v[124:127], a[36:39], v[156:159], v[124:127]
  global_load_dwordx4 a[136:139], v53, s[20:21] offset:-2048 sc1
  v_add_f32 v61, v61, v181
  v_mfma_f32_16x16x32_bf16 v[128:131], a[40:43], v[156:159], v[128:131]
  v_add_f32 v62, v62, v182
  v_add_f32 v63, v63, v183
  v_mfma_f32_16x16x32_bf16 v[132:135], a[44:47], v[156:159], v[132:135]
  s_waitcnt lgkmcnt(6)
  v_add_f32 v64, v64, v184
  v_add_f32 v65, v65, v185
  v_mfma_f32_16x16x32_bf16 v[160:163], v[44:47], v[136:139], v[160:163]
  global_load_dwordx4 a[140:143], v53, s[20:21] offset:-1024 sc1
  ds_read_b64_tr_b16 v[152:153], v28 offset:2048
  v_mfma_f32_16x16x32_bf16 v[168:171], v[136:139], v[136:139], v[168:171]
  ds_read_b64_tr_b16 v[154:155], v28 offset:3072
  ds_read_b64_tr_b16 v[156:157], v29 offset:2048
  v_mfma_f32_16x16x32_bf16 v[112:115], a[48:51], v[136:139], v[112:115]
  ds_read_b64_tr_b16 v[158:159], v29 offset:3072
  v_add_f32 v66, v66, v186
  v_mfma_f32_16x16x32_bf16 v[116:119], a[52:55], v[136:139], v[116:119]
  global_load_dwordx4 a[144:147], v53, s[20:21] offset:0 sc1
  v_add_f32 v67, v67, v187
  v_mfma_f32_16x16x32_bf16 v[120:123], a[56:59], v[136:139], v[120:123]
  s_waitcnt lgkmcnt(8)
  v_add_f32_dpp v56, v56, v56 row_ror:8 row_mask:0xf bank_mask:0xf
  v_add_f32_dpp v57, v57, v57 row_ror:8 row_mask:0xf bank_mask:0xf
  v_mfma_f32_16x16x32_bf16 v[164:167], v[44:47], v[140:143], v[164:167]
  v_add_f32_dpp v58, v58, v58 row_ror:8 row_mask:0xf bank_mask:0xf
  v_add_f32_dpp v59, v59, v59 row_ror:8 row_mask:0xf bank_mask:0xf
  v_mfma_f32_16x16x32_bf16 v[172:175], v[140:143], v[140:143], v[172:175]
  global_load_dwordx4 a[148:151], v53, s[20:21] offset:1024 sc1
  v_add_f32_dpp v60, v60, v60 row_ror:8 row_mask:0xf bank_mask:0xf
  v_mfma_f32_16x16x32_bf16 v[124:127], a[48:51], v[140:143], v[124:127]
  v_add_f32_dpp v61, v61, v61 row_ror:8 row_mask:0xf bank_mask:0xf
  v_add_f32_dpp v62, v62, v62 row_ror:8 row_mask:0xf bank_mask:0xf
  v_mfma_f32_16x16x32_bf16 v[128:131], a[52:55], v[140:143], v[128:131]
  v_add_f32_dpp v63, v63, v63 row_ror:8 row_mask:0xf bank_mask:0xf
  v_add_f32_dpp v64, v64, v64 row_ror:8 row_mask:0xf bank_mask:0xf
  v_mfma_f32_16x16x32_bf16 v[132:135], a[56:59], v[140:143], v[132:135]
  s_waitcnt lgkmcnt(6)
  s_waitcnt vmcnt(21)
  v_add_f32_dpp v65, v65, v65 row_ror:8 row_mask:0xf bank_mask:0xf
  v_mfma_f32_16x16x32_bf16 v[88:91], a[60:63], v[144:147], v[88:91]
  global_load_dwordx4 a[152:155], v53, s[20:21] offset:2048 sc1
  ds_read_b64_tr_b16 v[136:137], v28 offset:4096
  v_mfma_f32_16x16x32_bf16 v[92:95], a[64:67], v[144:147], v[92:95]
  ds_write_b64 v36, v[80:81] offset:0
  v_mfma_f32_16x16x32_bf16 v[96:99], a[68:71], v[144:147], v[96:99]
  s_waitcnt lgkmcnt(6)
  ds_write_b64 v36, v[82:83] offset:8
  v_mfma_f32_16x16x32_bf16 v[100:103], a[60:63], v[148:151], v[100:103]
  global_load_dwordx4 a[156:159], v53, s[20:21] offset:3072 sc1
  ds_read_b64_tr_b16 v[138:139], v28 offset:5120
  v_mfma_f32_16x16x32_bf16 v[104:107], a[64:67], v[148:151], v[104:107]
  ds_write_b32 v37, v72 offset:0
  v_mfma_f32_16x16x32_bf16 v[108:111], a[68:71], v[148:151], v[108:111]
  s_waitcnt lgkmcnt(7)
  s_waitcnt vmcnt(20)
  ds_read_b64_tr_b16 v[140:141], v29 offset:4096
  ds_read_b64_tr_b16 v[142:143], v29 offset:5120
  v_mfma_f32_16x16x32_bf16 v[88:91], a[72:75], v[152:155], v[88:91]
  v_add_u32 v53, 8192, v53
  global_load_dwordx4 a[160:163], v53, s[20:21] offset:-4096 sc1
  v_mfma_f32_16x16x32_bf16 v[92:95], a[76:79], v[152:155], v[92:95]
  ds_write_b64 v36, v[84:85] offset:1024
  v_mfma_f32_16x16x32_bf16 v[96:99], a[80:83], v[152:155], v[96:99]
  s_waitcnt lgkmcnt(8)
  ds_write_b64 v36, v[86:87] offset:1032
  v_mfma_f32_16x16x32_bf16 v[100:103], a[72:75], v[156:159], v[100:103]
  global_load_dwordx4 a[164:167], v53, s[20:21] offset:-3072 sc1
  ds_read_b64_tr_b16 v[144:145], v28 offset:6144
  v_mfma_f32_16x16x32_bf16 v[104:107], a[76:79], v[156:159], v[104:107]
  ds_read_b64_tr_b16 v[146:147], v28 offset:7168
  ds_read_b64_tr_b16 v[148:149], v29 offset:6144
  v_mfma_f32_16x16x32_bf16 v[108:111], a[80:83], v[156:159], v[108:111]
  s_waitcnt lgkmcnt(8)
  s_waitcnt vmcnt(19)
  ds_read_b64_tr_b16 v[150:151], v29 offset:7168
  v_mfma_f32_16x16x32_bf16 v[88:91], a[84:87], v[136:139], v[88:91]
  global_load_dwordx4 a[168:171], v53, s[20:21] offset:-2048 sc1
  ds_read_b64_tr_b16 v[152:153], v28 offset:8192
  v_mfma_f32_16x16x32_bf16 v[92:95], a[88:91], v[136:139], v[92:95]
  ds_write_b32 v37, v76 offset:256
  v_mfma_f32_16x16x32_bf16 v[96:99], a[92:95], v[136:139], v[96:99]
  s_waitcnt lgkmcnt(8)
  ds_write_b64 v36, v[168:169] offset:10240
  v_mfma_f32_16x16x32_bf16 v[100:103], a[84:87], v[140:143], v[100:103]
  global_load_dwordx4 a[172:175], v53, s[20:21] offset:-1024 sc1
  ds_read_b64_tr_b16 v[154:155], v28 offset:9216
  v_mfma_f32_16x16x32_bf16 v[104:107], a[88:91], v[140:143], v[104:107]
  ds_write_b64 v36, v[170:171] offset:10248
  v_mfma_f32_16x16x32_bf16 v[108:111], a[92:95], v[140:143], v[108:111]
  s_waitcnt lgkmcnt(7)
  s_waitcnt vmcnt(18)
  ds_read_b64_tr_b16 v[156:157], v29 offset:8192
  ds_read_b64_tr_b16 v[158:159], v29 offset:9216
  v_mfma_f32_16x16x32_bf16 v[88:91], a[96:99], v[144:147], v[88:91]
  global_load_dwordx4 a[176:179], v53, s[20:21] offset:0 sc1
  ds_read_b64_tr_b16 v[136:137], v30 offset:0
  v_mfma_f32_16x16x32_bf16 v[92:95], a[100:103], v[144:147], v[92:95]
  ds_write_b32 v37, v160 offset:10240
  v_mfma_f32_16x16x32_bf16 v[96:99], a[104:107], v[144:147], v[96:99]
  s_waitcnt lgkmcnt(9)
  ds_write_b64 v36, v[172:173] offset:11264
  v_mfma_f32_16x16x32_bf16 v[100:103], a[96:99], v[148:151], v[100:103]
  global_load_dwordx4 a[180:183], v53, s[20:21] offset:1024 sc1
  ds_read_b64_tr_b16 v[138:139], v30 offset:1024
  v_mfma_f32_16x16x32_bf16 v[104:107], a[100:103], v[148:151], v[104:107]
  ds_write_b64 v36, v[174:175] offset:11272
  v_mfma_f32_16x16x32_bf16 v[108:111], a[104:107], v[148:151], v[108:111]
  s_waitcnt lgkmcnt(8)
  s_waitcnt vmcnt(17)
  ds_read_b64_tr_b16 v[140:141], v31 offset:0
  ds_read_b64_tr_b16 v[142:143], v31 offset:1024
  v_mfma_f32_16x16x32_bf16 v[88:91], a[108:111], v[152:155], v[88:91]
  global_load_dwordx4 a[184:187], v53, s[20:21] offset:2048 sc1
  ds_read_b64_tr_b16 v[144:145], v30 offset:2048
  v_mfma_f32_16x16x32_bf16 v[92:95], a[112:115], v[152:155], v[92:95]
  ds_write_b32 v37, v164 offset:10496
  v_mfma_f32_16x16x32_bf16 v[96:99], a[116:119], v[152:155], v[96:99]
  s_waitcnt lgkmcnt(9)
  ds_read_b64_tr_b16 v[146:147], v30 offset:3072
  ds_read_b64_tr_b16 v[148:149], v31 offset:2048
  v_mfma_f32_16x16x32_bf16 v[100:103], a[108:111], v[156:159], v[100:103]
  global_load_dwordx4 a[188:191], v53, s[20:21] offset:3072 sc1
  ds_read_b64_tr_b16 v[150:151], v31 offset:3072
  v_mfma_f32_16x16x32_bf16 v[104:107], a[112:115], v[156:159], v[104:107]
  v_add_f32_dpp v66, v66, v66 row_ror:8 row_mask:0xf bank_mask:0xf
  v_add_f32_dpp v67, v67, v67 row_ror:8 row_mask:0xf bank_mask:0xf
  v_mfma_f32_16x16x32_bf16 v[108:111], a[116:119], v[156:159], v[108:111]
  s_waitcnt lgkmcnt(8)
  s_waitcnt vmcnt(16)
  v_add_f32_dpp v56, v56, v56 row_ror:4 row_mask:0xf bank_mask:0xf
  v_mfma_f32_16x16x32_bf16 v[88:91], a[120:123], v[136:139], v[88:91]
  v_add_u32 v53, 8192, v53
  global_load_dwordx4 a[192:195], v53, s[20:21] offset:-4096 sc1
  v_mfma_f32_16x16x32_bf16 v[92:95], a[124:127], v[136:139], v[92:95]
  ds_read_b64_tr_b16 v[152:153], v30 offset:4096
  ds_read_b64_tr_b16 v[154:155], v30 offset:5120
  v_mfma_f32_16x16x32_bf16 v[96:99], a[128:131], v[136:139], v[96:99]
  s_waitcnt lgkmcnt(7)
  global_load_dwordx4 a[196:199], v53, s[20:21] offset:-3072 sc1
  ds_read_b64_tr_b16 v[156:157], v31 offset:4096
  v_mfma_f32_16x16x32_bf16 v[100:103], a[120:123], v[140:143], v[100:103]
  ds_read_b64_tr_b16 v[158:159], v31 offset:5120
  v_add_f32_dpp v57, v57, v57 row_ror:4 row_mask:0xf bank_mask:0xf
  v_mfma_f32_16x16x32_bf16 v[104:107], a[124:127], v[140:143], v[104:107]
  global_load_dwordx4 a[200:203], v53, s[20:21] offset:-2048 sc1
  v_add_f32_dpp v58, v58, v58 row_ror:4 row_mask:0xf bank_mask:0xf
  v_mfma_f32_16x16x32_bf16 v[108:111], a[128:131], v[140:143], v[108:111]
  s_waitcnt lgkmcnt(6)
  s_waitcnt vmcnt(15)
  v_add_f32_dpp v59, v59, v59 row_ror:4 row_mask:0xf bank_mask:0xf
  v_mfma_f32_16x16x32_bf16 v[88:91], a[132:135], v[144:147], v[88:91]
  global_load_dwordx4 a[204:207], v53, s[20:21] offset:-1024 sc1
  ds_read_b64_tr_b16 v[136:137], v30 offset:6144
  v_mfma_f32_16x16x32_bf16 v[92:95], a[136:139], v[144:147], v[92:95]
  ds_read_b64_tr_b16 v[138:139], v30 offset:7168
  ds_read_b64_tr_b16 v[140:141], v31 offset:6144
  v_mfma_f32_16x16x32_bf16 v[96:99], a[140:143], v[144:147], v[96:99]
  s_waitcnt lgkmcnt(7)
  global_load_dwordx4 a[208:211], v53, s[20:21] offset:0 sc1
  ds_read_b64_tr_b16 v[142:143], v31 offset:7168
  v_mfma_f32_16x16x32_bf16 v[100:103], a[132:135], v[148:151], v[100:103]
  v_add_f32_dpp v60, v60, v60 row_ror:4 row_mask:0xf bank_mask:0xf
  v_add_f32_dpp v61, v61, v61 row_ror:4 row_mask:0xf bank_mask:0xf
  v_mfma_f32_16x16x32_bf16 v[104:107], a[136:139], v[148:151], v[104:107]
  s_barrier
  global_load_dwordx4 a[212:215], v53, s[20:21] offset:1024 sc1
  v_add_f32_dpp v62, v62, v62 row_ror:4 row_mask:0xf bank_mask:0xf
  v_mfma_f32_16x16x32_bf16 v[108:111], a[140:143], v[148:151], v[108:111]
  s_waitcnt lgkmcnt(6)
  s_waitcnt vmcnt(15)
  v_add_f32_dpp v63, v63, v63 row_ror:4 row_mask:0xf bank_mask:0xf
  v_mfma_f32_16x16x32_bf16 v[88:91], a[144:147], v[152:155], v[88:91]
  ds_read_b64_tr_b16 v[144:145], v30 offset:8192
  ds_read_b64_tr_b16 v[146:147], v30 offset:9216
  v_mfma_f32_16x16x32_bf16 v[92:95], a[148:151], v[152:155], v[92:95]
  global_load_dwordx4 a[216:219], v53, s[20:21] offset:2048 sc1
  ds_read_b64_tr_b16 v[148:149], v31 offset:8192
  v_mfma_f32_16x16x32_bf16 v[96:99], a[152:155], v[152:155], v[96:99]
  s_waitcnt lgkmcnt(7)
  ds_read_b64_tr_b16 v[150:151], v31 offset:9216
  v_add_f32_dpp v64, v64, v64 row_ror:4 row_mask:0xf bank_mask:0xf
  v_mfma_f32_16x16x32_bf16 v[100:103], a[144:147], v[156:159], v[100:103]
  global_load_dwordx4 a[220:223], v53, s[20:21] offset:3072 sc1
  v_add_f32_dpp v65, v65, v65 row_ror:4 row_mask:0xf bank_mask:0xf
  v_mfma_f32_16x16x32_bf16 v[104:107], a[148:151], v[156:159], v[104:107]
  buffer_load_dword v8, v6, s[20:23], 0 offen offset:768 sc1
  v_mfma_f32_16x16x32_bf16 v[108:111], a[152:155], v[156:159], v[108:111]
  s_waitcnt lgkmcnt(6)
  s_waitcnt vmcnt(15)
  v_add_f32_dpp v66, v66, v66 row_ror:4 row_mask:0xf bank_mask:0xf
  v_mfma_f32_16x16x32_bf16 v[88:91], a[156:159], v[136:139], v[88:91]
  v_add_u32 v53, 8192, v53
  global_load_dwordx4 a[224:227], v53, s[20:21] offset:-4096 sc1
  v_mfma_f32_16x16x32_bf16 v[92:95], a[160:163], v[136:139], v[92:95]
  ds_read_b64_tr_b16 v[152:153], v32 offset:0
  ds_read_b64_tr_b16 v[154:155], v32 offset:1024
  v_mfma_f32_16x16x32_bf16 v[96:99], a[164:167], v[136:139], v[96:99]
  s_waitcnt lgkmcnt(6)
  global_load_dwordx4 a[228:231], v53, s[20:21] offset:-3072 sc1
  ds_read_b64_tr_b16 v[156:157], v33 offset:0
  v_mfma_f32_16x16x32_bf16 v[100:103], a[156:159], v[140:143], v[100:103]
  ds_read_b64_tr_b16 v[158:159], v33 offset:1024
  v_add_f32_dpp v67, v67, v67 row_ror:4 row_mask:0xf bank_mask:0xf
  v_mfma_f32_16x16x32_bf16 v[104:107], a[160:163], v[140:143], v[104:107]
  global_load_dwordx4 a[232:235], v53, s[20:21] offset:-2048 sc1
  v_add_f32_dpp v56, v56, v56 row_ror:2 row_mask:0xf bank_mask:0xf
  v_mfma_f32_16x16x32_bf16 v[108:111], a[164:167], v[140:143], v[108:111]
  s_waitcnt lgkmcnt(6)
  s_waitcnt vmcnt(15)
  v_add_f32_dpp v57, v57, v57 row_ror:2 row_mask:0xf bank_mask:0xf
  v_mfma_f32_16x16x32_bf16 v[88:91], a[168:171], v[144:147], v[88:91]
  global_load_dwordx4 a[236:239], v53, s[20:21] offset:-1024 sc1
  ds_read_b64_tr_b16 v[136:137], v32 offset:2048
  v_mfma_f32_16x16x32_bf16 v[92:95], a[172:175], v[144:147], v[92:95]
  ds_read_b64_tr_b16 v[138:139], v32 offset:3072
  ds_read_b64_tr_b16 v[140:141], v33 offset:2048
  v_mfma_f32_16x16x32_bf16 v[96:99], a[176:179], v[144:147], v[96:99]
  s_waitcnt lgkmcnt(7)
  ds_read_b64_tr_b16 v[142:143], v33 offset:3072
  v_add_f32_dpp v58, v58, v58 row_ror:2 row_mask:0xf bank_mask:0xf
  v_mfma_f32_16x16x32_bf16 v[100:103], a[168:171], v[148:151], v[100:103]
  v_add_f32_dpp v59, v59, v59 row_ror:2 row_mask:0xf bank_mask:0xf
  v_add_f32_dpp v60, v60, v60 row_ror:2 row_mask:0xf bank_mask:0xf
  v_mfma_f32_16x16x32_bf16 v[104:107], a[172:175], v[148:151], v[104:107]
  v_add_f32_dpp v61, v61, v61 row_ror:2 row_mask:0xf bank_mask:0xf
  v_add_f32_dpp v62, v62, v62 row_ror:2 row_mask:0xf bank_mask:0xf
  v_mfma_f32_16x16x32_bf16 v[108:111], a[176:179], v[148:151], v[108:111]
  s_waitcnt lgkmcnt(6)
  s_waitcnt vmcnt(13)
  v_add_f32_dpp v63, v63, v63 row_ror:2 row_mask:0xf bank_mask:0xf
  v_mfma_f32_16x16x32_bf16 v[88:91], a[180:183], v[152:155], v[88:91]
  v_add_u32 v53, s19, v4
  global_load_dwordx4 v[188:191], v53, s[20:21] offset:0 sc1
  v_mfma_f32_16x16x32_bf16 v[92:95], a[184:187], v[152:155], v[92:95]
  ds_read_b64_tr_b16 v[144:145], v32 offset:4096
  ds_read_b64_tr_b16 v[146:147], v32 offset:5120
  v_mfma_f32_16x16x32_bf16 v[96:99], a[188:191], v[152:155], v[96:99]
  s_waitcnt lgkmcnt(6)
  ds_read_b64_tr_b16 v[148:149], v33 offset:4096
  ds_read_b64_tr_b16 v[150:151], v33 offset:5120
  v_mfma_f32_16x16x32_bf16 v[100:103], a[180:183], v[156:159], v[100:103]
  v_add_f32_dpp v64, v64, v64 row_ror:2 row_mask:0xf bank_mask:0xf
  v_add_f32_dpp v65, v65, v65 row_ror:2 row_mask:0xf bank_mask:0xf
  v_mfma_f32_16x16x32_bf16 v[104:107], a[184:187], v[156:159], v[104:107]
  v_add_f32_dpp v66, v66, v66 row_ror:2 row_mask:0xf bank_mask:0xf
  v_add_f32_dpp v67, v67, v67 row_ror:2 row_mask:0xf bank_mask:0xf
  v_mfma_f32_16x16x32_bf16 v[108:111], a[188:191], v[156:159], v[108:111]
  s_waitcnt lgkmcnt(6)
  s_waitcnt vmcnt(11)
  v_add_f32_dpp v56, v56, v56 row_ror:1 row_mask:0xf bank_mask:0xf
  v_mfma_f32_16x16x32_bf16 v[88:91], a[192:195], v[136:139], v[88:91]
  global_load_dwordx4 v[192:195], v53, s[20:21] offset:1024 sc1
  ds_read_b64_tr_b16 v[152:153], v32 offset:6144
  v_mfma_f32_16x16x32_bf16 v[92:95], a[196:199], v[136:139], v[92:95]
  ds_read_b64_tr_b16 v[154:155], v32 offset:7168
  ds_read_b64_tr_b16 v[156:157], v33 offset:6144
  v_mfma_f32_16x16x32_bf16 v[96:99], a[200:203], v[136:139], v[96:99]
  s_waitcnt lgkmcnt(7)
  ds_read_b64_tr_b16 v[158:159], v33 offset:7168
  v_add_f32_dpp v57, v57, v57 row_ror:1 row_mask:0xf bank_mask:0xf
  v_mfma_f32_16x16x32_bf16 v[100:103], a[192:195], v[140:143], v[100:103]
  v_add_f32_dpp v58, v58, v58 row_ror:1 row_mask:0xf bank_mask:0xf
  v_add_f32_dpp v59, v59, v59 row_ror:1 row_mask:0xf bank_mask:0xf
  v_mfma_f32_16x16x32_bf16 v[104:107], a[196:199], v[140:143], v[104:107]
  v_add_f32_dpp v60, v60, v60 row_ror:1 row_mask:0xf bank_mask:0xf
  v_add_f32_dpp v61, v61, v61 row_ror:1 row_mask:0xf bank_mask:0xf
  v_mfma_f32_16x16x32_bf16 v[108:111], a[200:203], v[140:143], v[108:111]
  s_waitcnt lgkmcnt(6)
  s_waitcnt vmcnt(9)
  v_add_f32_dpp v62, v62, v62 row_ror:1 row_mask:0xf bank_mask:0xf
  v_mfma_f32_16x16x32_bf16 v[88:91], a[204:207], v[144:147], v[88:91]
  global_load_dwordx4 v[196:199], v53, s[20:21] offset:2048 sc1
  ds_read_b64_tr_b16 v[136:137], v32 offset:8192
  v_mfma_f32_16x16x32_bf16 v[92:95], a[208:211], v[144:147], v[92:95]
  ds_read_b64_tr_b16 v[138:139], v32 offset:9216
  ds_read_b64_tr_b16 v[140:141], v33 offset:8192
  v_mfma_f32_16x16x32_bf16 v[96:99], a[212:215], v[144:147], v[96:99]
  s_waitcnt lgkmcnt(7)
  ds_read_b64_tr_b16 v[142:143], v33 offset:9216
  v_add_f32_dpp v63, v63, v63 row_ror:1 row_mask:0xf bank_mask:0xf
  v_mfma_f32_16x16x32_bf16 v[100:103], a[204:207], v[148:151], v[100:103]
  v_add_f32_dpp v64, v64, v64 row_ror:1 row_mask:0xf bank_mask:0xf
  v_add_f32_dpp v65, v65, v65 row_ror:1 row_mask:0xf bank_mask:0xf
  v_mfma_f32_16x16x32_bf16 v[104:107], a[208:211], v[148:151], v[104:107]
  v_add_f32_dpp v66, v66, v66 row_ror:1 row_mask:0xf bank_mask:0xf
  v_add_f32_dpp v67, v67, v67 row_ror:1 row_mask:0xf bank_mask:0xf
  v_mfma_f32_16x16x32_bf16 v[108:111], a[212:215], v[148:151], v[108:111]
  s_waitcnt lgkmcnt(6)
  s_waitcnt vmcnt(6)
  v_mov_b32 v68, v64
  v_mfma_f32_16x16x32_bf16 v[88:91], a[216:219], v[152:155], v[88:91]
  global_load_dwordx4 v[200:203], v53, s[20:21] offset:3072 sc1
  ds_read_b64_tr_b16 v[144:145], v28 offset:40960
  v_mfma_f32_16x16x32_bf16 v[92:95], a[220:223], v[152:155], v[92:95]
  ds_read_b64_tr_b16 v[146:147], v28 offset:41984
  ds_read_b64_tr_b16 v[148:149], v29 offset:40960
  v_mfma_f32_16x16x32_bf16 v[96:99], a[224:227], v[152:155], v[96:99]
  s_waitcnt lgkmcnt(7)
  ds_read_b64_tr_b16 v[150:151], v29 offset:41984
  v_mov_b32 v69, v65
  v_mfma_f32_16x16x32_bf16 v[100:103], a[216:219], v[156:159], v[100:103]
  v_mov_b32 v70, v66
  v_mov_b32 v71, v67
  v_mfma_f32_16x16x32_bf16 v[104:107], a[220:223], v[156:159], v[104:107]
  v_permlane16_swap_b32 v64, v68
  v_permlane16_swap_b32 v65, v69
  v_mfma_f32_16x16x32_bf16 v[108:111], a[224:227], v[156:159], v[108:111]
  s_waitcnt lgkmcnt(6)
  s_waitcnt vmcnt(4)
  v_permlane16_swap_b32 v66, v70
  v_mfma_f32_16x16x32_bf16 v[88:91], a[228:231], v[136:139], v[88:91]
  v_add_u32 v53, 8192, v53
  global_load_dwordx4 v[204:207], v53, s[20:21] offset:-4096 sc1
  v_mfma_f32_16x16x32_bf16 v[92:95], a[232:235], v[136:139], v[92:95]
  ds_read_b64_tr_b16 v[152:153], v28 offset:43008
  ds_read_b64_tr_b16 v[154:155], v28 offset:44032
  v_mfma_f32_16x16x32_bf16 v[96:99], a[236:239], v[136:139], v[96:99]
  s_waitcnt lgkmcnt(6)
  ds_read_b64_tr_b16 v[156:157], v29 offset:43008
  ds_read_b64_tr_b16 v[158:159], v29 offset:44032
  v_mfma_f32_16x16x32_bf16 v[100:103], a[228:231], v[140:143], v[100:103]
  v_permlane16_swap_b32 v67, v71
  ds_read2st64_b32 v[18:19], v39 offset0:0 offset1:2
  v_mfma_f32_16x16x32_bf16 v[104:107], a[232:235], v[140:143], v[104:107]
  ds_read2st64_b32 v[20:21], v39 offset0:4 offset1:6
  ds_read2st64_b32 v[22:23], v38 offset0:0 offset1:8
  v_mfma_f32_16x16x32_bf16 v[108:111], a[236:239], v[140:143], v[108:111]
  s_waitcnt lgkmcnt(9)
  global_load_dwordx4 v[208:211], v53, s[20:21] offset:-3072 sc1
  ds_read2st64_b32 v[24:25], v38 offset0:16 offset1:24
  v_mfma_f32_16x16x32_bf16 v[112:115], a[60:63], v[144:147], v[112:115]
  v_cmp_ne_u32 vcc, 16, v8
  s_cbranch_vccnz slow_19
back_20:
  s_barrier
  v_mfma_f32_16x16x32_bf16 v[116:119], a[64:67], v[144:147], v[116:119]
  s_waitcnt lgkmcnt(0)
  ds_read_b64_tr_b16 v[136:137], v28 offset:45056
  ds_read_b64_tr_b16 v[138:139], v28 offset:46080
  v_mfma_f32_16x16x32_bf16 v[120:123], a[68:71], v[144:147], v[120:123]
  ds_read_b64_tr_b16 v[140:141], v29 offset:45056
  ds_read_b64_tr_b16 v[142:143], v29 offset:46080
  v_mfma_f32_16x16x32_bf16 v[124:127], a[60:63], v[148:151], v[124:127]
  v_add_f32 v18, v18, v19
  v_add_f32 v20, v20, v21
  v_mfma_f32_16x16x32_bf16 v[128:131], a[64:67], v[148:151], v[128:131]
  s_add_u32 m0, s17, 0
  v_add_u32 v0, 1265536, v0
  global_load_lds_dwordx4 v0, s[20:21] offset:0 sc1
  v_mfma_f32_16x16x32_bf16 v[132:135], a[68:71], v[148:151], v[132:135]
  v_add_f32 v22, v22, v23
  v_add_f32 v24, v24, v25
  v_mfma_f32_16x16x32_bf16 v[112:115], a[72:75], v[152:155], v[112:115]
  ds_read_b64_tr_b16 v[144:145], v28 offset:47104
  ds_read_b64_tr_b16 v[146:147], v28 offset:48128
  v_mfma_f32_16x16x32_bf16 v[116:119], a[76:79], v[152:155], v[116:119]
  ds_read_b64_tr_b16 v[148:149], v29 offset:47104
  ds_read_b64_tr_b16 v[150:151], v29 offset:48128
  v_mfma_f32_16x16x32_bf16 v[120:123], a[80:83], v[152:155], v[120:123]
  v_add_f32 v18, v18, v20
  v_add_f32 v22, v22, v24
  v_mfma_f32_16x16x32_bf16 v[124:127], a[72:75], v[156:159], v[124:127]
  global_load_lds_dwordx4 v0, s[20:21] offset:1024 sc1
  v_mul_f32 v9, -0.0015625, v18
  v_mfma_f32_16x16x32_bf16 v[128:131], a[76:79], v[156:159], v[128:131]
  v_mul_f32 v11, 0.0015625, v22
  v_fma_f32 v11, -v9, v9, v11
  v_mfma_f32_16x16x32_bf16 v[132:135], a[80:83], v[156:159], v[132:135]
  s_waitcnt lgkmcnt(6)
  v_max_f32 v11, 0, v11
  v_add_f32 v11, 1e-05, v11
  v_mfma_f32_16x16x32_bf16 v[112:115], a[84:87], v[136:139], v[112:115]
  v_rsq_f32 v10, v11
  v_mfma_f32_16x16x32_bf16 v[116:119], a[88:91], v[136:139], v[116:119]
  ds_read_b64_tr_b16 v[152:153], v28 offset:49152
  ds_read_b64_tr_b16 v[154:155], v28 offset:50176
  v_mfma_f32_16x16x32_bf16 v[120:123], a[92:95], v[136:139], v[120:123]
  s_waitcnt lgkmcnt(6)
  global_load_lds_dwordx4 v0, s[20:21] offset:2048 sc1
  ds_read_b64_tr_b16 v[156:157], v29 offset:49152
  v_mfma_f32_16x16x32_bf16 v[124:127], a[84:87], v[140:143], v[124:127]
  ds_read_b64_tr_b16 v[158:159], v29 offset:50176
  v_mov_b32 v12, v9
  v_mfma_f32_16x16x32_bf16 v[128:131], a[88:91], v[140:143], v[128:131]
  v_mul_f32 v10, -1.4426950408889634, v10
  v_mov_b32 v15, v9
  v_mfma_f32_16x16x32_bf16 v[132:135], a[92:95], v[140:143], v[132:135]
  s_waitcnt lgkmcnt(6)
  v_mov_b32 v14, v11
  v_mov_b32 v17, v11
  v_mfma_f32_16x16x32_bf16 v[112:115], a[96:99], v[144:147], v[112:115]
  ds_read_b64_tr_b16 v[136:137], v30 offset:40960
  ds_read_b64_tr_b16 v[138:139], v30 offset:41984
  v_mfma_f32_16x16x32_bf16 v[116:119], a[100:103], v[144:147], v[116:119]
  global_load_lds_dwordx4 v0, s[20:21] offset:3072 sc1
  ds_read_b64_tr_b16 v[140:141], v31 offset:40960
  v_mfma_f32_16x16x32_bf16 v[120:123], a[104:107], v[144:147], v[120:123]
  s_waitcnt lgkmcnt(7)
  ds_read_b64_tr_b16 v[142:143], v31 offset:41984
  v_mov_b32 v13, v10
  v_mfma_f32_16x16x32_bf16 v[124:127], a[96:99], v[148:151], v[124:127]
  v_mov_b32 v16, v10
  v_permlane16_swap_b32 v12, v15
  v_mfma_f32_16x16x32_bf16 v[128:131], a[100:103], v[148:151], v[128:131]
  v_permlane16_swap_b32 v14, v17
  v_permlane16_swap_b32 v13, v16
  v_mfma_f32_16x16x32_bf16 v[132:135], a[104:107], v[148:151], v[132:135]
  s_waitcnt lgkmcnt(6)
  v_fmac_f32 v88, v12, v56
  v_fmac_f32 v89, v12, v57
  v_mfma_f32_16x16x32_bf16 v[112:115], a[108:111], v[152:155], v[112:115]
  s_add_u32 m0, s17, 4096
  v_add_u32 v0, 4096, v0
  global_load_lds_dwordx4 v0, s[20:21] offset:0 sc1
  v_mfma_f32_16x16x32_bf16 v[116:119], a[112:115], v[152:155], v[116:119]
  ds_read_b64_tr_b16 v[144:145], v30 offset:43008
  ds_read_b64_tr_b16 v[146:147], v30 offset:44032
  v_mfma_f32_16x16x32_bf16 v[120:123], a[116:119], v[152:155], v[120:123]
  s_waitcnt lgkmcnt(6)
  ds_read_b64_tr_b16 v[148:149], v31 offset:43008
  ds_read_b64_tr_b16 v[150:151], v31 offset:44032
  v_mfma_f32_16x16x32_bf16 v[124:127], a[108:111], v[156:159], v[124:127]
  v_fmac_f32 v90, v12, v58
  v_fmac_f32 v91, v12, v59
  v_mfma_f32_16x16x32_bf16 v[128:131], a[112:115], v[156:159], v[128:131]
  v_fmac_f32 v92, v12, v60
  v_fmac_f32 v93, v12, v61
  v_mfma_f32_16x16x32_bf16 v[132:135], a[116:119], v[156:159], v[132:135]
  s_waitcnt lgkmcnt(6)
  global_load_lds_dwordx4 v0, s[20:21] offset:1024 sc1
  v_fmac_f32 v94, v12, v62
  v_mfma_f32_16x16x32_bf16 v[112:115], a[120:123], v[136:139], v[112:115]
  ds_read_b64_tr_b16 v[152:153], v30 offset:45056
  ds_read_b64_tr_b16 v[154:155], v30 offset:46080
  v_mfma_f32_16x16x32_bf16 v[116:119], a[124:127], v[136:139], v[116:119]
  ds_read_b64_tr_b16 v[156:157], v31 offset:45056
  ds_read_b64_tr_b16 v[158:159], v31 offset:46080
  v_mfma_f32_16x16x32_bf16 v[120:123], a[128:131], v[136:139], v[120:123]
  s_waitcnt lgkmcnt(8)
  v_fmac_f32 v95, v12, v63
  v_mul_f32 v92, v88, v92
  v_mfma_f32_16x16x32_bf16 v[124:127], a[120:123], v[140:143], v[124:127]
  v_mul_f32 v93, v89, v93
  v_mul_f32 v94, v90, v94
  v_mfma_f32_16x16x32_bf16 v[128:131], a[124:127], v[140:143], v[128:131]
  global_load_lds_dwordx4 v0, s[20:21] offset:2048 sc1
  v_mul_f32 v95, v91, v95
  v_mfma_f32_16x16x32_bf16 v[132:135], a[128:131], v[140:143], v[132:135]
  s_waitcnt lgkmcnt(6)
  v_mul_f32 v88, v88, v13
  v_mul_f32 v89, v89, v13
  v_mfma_f32_16x16x32_bf16 v[112:115], a[132:135], v[144:147], v[112:115]
  v_exp_f32 v88, v88
  v_mfma_f32_16x16x32_bf16 v[116:119], a[136:139], v[144:147], v[116:119]
  v_exp_f32 v89, v89
  v_mfma_f32_16x16x32_bf16 v[120:123], a[140:143], v[144:147], v[120:123]
  s_waitcnt lgkmcnt(4)
  ds_read_b64_tr_b16 v[136:137], v30 offset:47104
  ds_read_b64_tr_b16 v[138:139], v30 offset:48128
  v_mfma_f32_16x16x32_bf16 v[124:127], a[132:135], v[148:151], v[124:127]
  global_load_lds_dwordx4 v0, s[20:21] offset:3072 sc1
  ds_read_b64_tr_b16 v[140:141], v31 offset:47104
  v_mfma_f32_16x16x32_bf16 v[128:131], a[136:139], v[148:151], v[128:131]
  ds_read_b64_tr_b16 v[142:143], v31 offset:48128
  v_mul_f32 v90, v90, v13
  v_mfma_f32_16x16x32_bf16 v[132:135], a[140:143], v[148:151], v[132:135]
  s_waitcnt lgkmcnt(6)
  v_exp_f32 v90, v90
  v_mfma_f32_16x16x32_bf16 v[112:115], a[144:147], v[152:155], v[112:115]
  ds_read_b64_tr_b16 v[144:145], v30 offset:49152
  ds_read_b64_tr_b16 v[146:147], v30 offset:50176
  v_mfma_f32_16x16x32_bf16 v[116:119], a[148:151], v[152:155], v[116:119]
  ds_read_b64_tr_b16 v[148:149], v31 offset:49152
  ds_read_b64_tr_b16 v[150:151], v31 offset:50176
  v_mfma_f32_16x16x32_bf16 v[120:123], a[152:155], v[152:155], v[120:123]
  s_waitcnt lgkmcnt(8)
  s_add_u32 m0, s17, 8192
  v_add_u32 v0, 4096, v0
  global_load_lds_dwordx4 v0, s[20:21] offset:0 sc1
  v_mfma_f32_16x16x32_bf16 v[124:127], a[144:147], v[156:159], v[124:127]
  v_mul_f32 v91, v91, v13
  v_fma_f32 v88, v88, v14, v14
  v_mfma_f32_16x16x32_bf16 v[128:131], a[148:151], v[156:159], v[128:131]
  v_exp_f32 v91, v91
  v_mfma_f32_16x16x32_bf16 v[132:135], a[152:155], v[156:159], v[132:135]
  s_waitcnt lgkmcnt(6)
  v_rcp_f32 v88, v88
  v_mfma_f32_16x16x32_bf16 v[112:115], a[156:159], v[136:139], v[112:115]
  ds_read_b64_tr_b16 v[152:153], v32 offset:40960
  ds_read_b64_tr_b16 v[154:155], v32 offset:41984
  v_mfma_f32_16x16x32_bf16 v[116:119], a[160:163], v[136:139], v[116:119]
  global_load_lds_dwordx4 v0, s[20:21] offset:1024 sc1
  ds_read_b64_tr_b16 v[156:157], v33 offset:40960
  v_mfma_f32_16x16x32_bf16 v[120:123], a[164:167], v[136:139], v[120:123]
  s_waitcnt lgkmcnt(7)
  ds_read_b64_tr_b16 v[158:159], v33 offset:41984
  v_fma_f32 v89, v89, v14, v14
  v_mfma_f32_16x16x32_bf16 v[124:127], a[156:159], v[140:143], v[124:127]
  v_rcp_f32 v89, v89
  v_mfma_f32_16x16x32_bf16 v[128:131], a[160:163], v[140:143], v[128:131]
  v_fma_f32 v90, v90, v14, v14
  v_fma_f32 v91, v91, v14, v14
  v_mfma_f32_16x16x32_bf16 v[132:135], a[164:167], v[140:143], v[132:135]
  s_waitcnt lgkmcnt(6)
  v_rcp_f32 v90, v90
  v_mfma_f32_16x16x32_bf16 v[112:115], a[168:171], v[144:147], v[112:115]
  global_load_dwordx4 v[212:215], v53, s[20:21] offset:-2048 sc1
  ds_read_b64_tr_b16 v[136:137], v32 offset:43008
  v_mfma_f32_16x16x32_bf16 v[116:119], a[172:175], v[144:147], v[116:119]
  v_rcp_f32 v91, v91
  v_mfma_f32_16x16x32_bf16 v[120:123], a[176:179], v[144:147], v[120:123]
  s_waitcnt lgkmcnt(5)
  ds_read_b64_tr_b16 v[138:139], v32 offset:44032
  ds_read_b64_tr_b16 v[140:141], v33 offset:43008
  v_mfma_f32_16x16x32_bf16 v[124:127], a[168:171], v[148:151], v[124:127]
  ds_read_b64_tr_b16 v[142:143], v33 offset:44032
  v_mul_f32 v92, v92, v88
  v_mfma_f32_16x16x32_bf16 v[128:131], a[172:175], v[148:151], v[128:131]
  v_mul_f32 v93, v93, v89
  v_mul_f32 v94, v94, v90
  v_mfma_f32_16x16x32_bf16 v[132:135], a[176:179], v[148:151], v[132:135]
  s_waitcnt lgkmcnt(6)
  global_load_dwordx4 v[216:219], v53, s[20:21] offset:-1024 sc1
  v_mul_f32 v95, v95, v91
  v_mfma_f32_16x16x32_bf16 v[112:115], a[180:183], v[152:155], v[112:115]
  ds_read_b64_tr_b16 v[144:145], v32 offset:45056
  ds_read_b64_tr_b16 v[146:147], v32 offset:46080
  v_mfma_f32_16x16x32_bf16 v[116:119], a[184:187], v[152:155], v[116:119]
  ds_read_b64_tr_b16 v[148:149], v33 offset:45056
  ds_read_b64_tr_b16 v[150:151], v33 offset:46080
  v_mfma_f32_16x16x32_bf16 v[120:123], a[188:191], v[152:155], v[120:123]
  s_waitcnt lgkmcnt(8)
  v_cvt_pk_bf16_f32 v18, v92, v93
  v_cvt_pk_bf16_f32 v19, v94, v95
  v_mfma_f32_16x16x32_bf16 v[124:127], a[180:183], v[156:159], v[124:127]
  v_fmac_f32 v100, v15, v56
  v_fmac_f32 v101, v15, v57
  v_mfma_f32_16x16x32_bf16 v[128:131], a[184:187], v[156:159], v[128:131]
  global_load_dwordx4 v[220:223], v53, s[20:21] offset:0 sc1
  v_fmac_f32 v102, v15, v58
  v_mfma_f32_16x16x32_bf16 v[132:135], a[188:191], v[156:159], v[132:135]
  s_waitcnt lgkmcnt(6)
  v_fmac_f32 v103, v15, v59
  v_fmac_f32 v104, v15, v60
  v_mfma_f32_16x16x32_bf16 v[112:115], a[192:195], v[136:139], v[112:115]
  ds_read_b64_tr_b16 v[152:153], v32 offset:47104
  ds_read_b64_tr_b16 v[154:155], v32 offset:48128
  v_mfma_f32_16x16x32_bf16 v[116:119], a[196:199], v[136:139], v[116:119]
  ds_read_b64_tr_b16 v[156:157], v33 offset:47104
  ds_read_b64_tr_b16 v[158:159], v33 offset:48128
  v_mfma_f32_16x16x32_bf16 v[120:123], a[200:203], v[136:139], v[120:123]
  s_waitcnt lgkmcnt(8)
  v_fmac_f32 v105, v15, v61
  v_fmac_f32 v106, v15, v62
  v_mfma_f32_16x16x32_bf16 v[124:127], a[192:195], v[140:143], v[124:127]
  global_load_dwordx4 v[224:227], v53, s[20:21] offset:1024 sc1
  v_fmac_f32 v107, v15, v63
  v_mfma_f32_16x16x32_bf16 v[128:131], a[196:199], v[140:143], v[128:131]
  v_mul_f32 v104, v100, v104
  v_mul_f32 v105, v101, v105
  v_mfma_f32_16x16x32_bf16 v[132:135], a[200:203], v[140:143], v[132:135]
  s_waitcnt lgkmcnt(6)
  v_mul_f32 v106, v102, v106
  v_mul_f32 v107, v103, v107
  v_mfma_f32_16x16x32_bf16 v[112:115], a[204:207], v[144:147], v[112:115]
  ds_read_b64_tr_b16 v[136:137], v32 offset:49152
  ds_read_b64_tr_b16 v[138:139], v32 offset:50176
  v_mfma_f32_16x16x32_bf16 v[116:119], a[208:211], v[144:147], v[116:119]
  ds_read_b64_tr_b16 v[140:141], v33 offset:49152
  ds_read_b64_tr_b16 v[142:143], v33 offset:50176
  v_mfma_f32_16x16x32_bf16 v[120:123], a[212:215], v[144:147], v[120:123]
  s_waitcnt lgkmcnt(8)
  global_load_dwordx4 v[228:231], v53, s[20:21] offset:2048 sc1
  v_mul_f32 v100, v100, v16
  v_mfma_f32_16x16x32_bf16 v[124:127], a[204:207], v[148:151], v[124:127]
  v_exp_f32 v100, v100
  v_mfma_f32_16x16x32_bf16 v[128:131], a[208:211], v[148:151], v[128:131]
  v_mul_f32 v101, v101, v16
  v_mul_f32 v102, v102, v16
  v_mfma_f32_16x16x32_bf16 v[132:135], a[212:215], v[148:151], v[132:135]
  s_waitcnt lgkmcnt(6)
  v_exp_f32 v101, v101
  v_mfma_f32_16x16x32_bf16 v[112:115], a[216:219], v[152:155], v[112:115]
  s_waitcnt vmcnt(13)
  v_exp_f32 v102, v102
  v_mfma_f32_16x16x32_bf16 v[116:119], a[220:223], v[152:155], v[116:119]
  global_load_dwordx4 v[232:235], v53, s[20:21] offset:3072 sc1
  ds_read_b64_tr_b16 v[144:145], v26 offset:0
  v_mfma_f32_16x16x32_bf16 v[120:123], a[224:227], v[152:155], v[120:123]
  s_waitcnt lgkmcnt(5)
  ds_read_b64_tr_b16 v[146:147], v26 offset:1024
  ds_read_b64_tr_b16 v[148:149], v27 offset:0
  v_mfma_f32_16x16x32_bf16 v[124:127], a[216:219], v[156:159], v[124:127]
  ds_read_b64_tr_b16 v[150:151], v27 offset:1024
  v_mul_f32 v103, v103, v16
  v_mfma_f32_16x16x32_bf16 v[128:131], a[220:223], v[156:159], v[128:131]
  v_exp_f32 v103, v103
  v_mfma_f32_16x16x32_bf16 v[132:135], a[224:227], v[156:159], v[132:135]
  s_waitcnt lgkmcnt(6)
  v_fma_f32 v100, v100, v17, v17
  v_fma_f32 v101, v101, v17, v17
  v_mfma_f32_16x16x32_bf16 v[112:115], a[228:231], v[136:139], v[112:115]
  s_waitcnt vmcnt(12)
  v_add_u32 v53, 8192, v53
  global_load_dwordx4 v[236:239], v53, s[20:21] offset:-4096 sc1
  v_mfma_f32_16x16x32_bf16 v[116:119], a[232:235], v[136:139], v[116:119]
  v_rcp_f32 v100, v100
  v_mfma_f32_16x16x32_bf16 v[120:123], a[236:239], v[136:139], v[120:123]
  s_waitcnt lgkmcnt(4)
  v_rcp_f32 v101, v101
  v_mfma_f32_16x16x32_bf16 v[124:127], a[228:231], v[140:143], v[124:127]
  ds_read_b64_tr_b16 v[152:153], v26 offset:2048
  ds_read_b64_tr_b16 v[154:155], v26 offset:3072
  v_mfma_f32_16x16x32_bf16 v[128:131], a[232:235], v[140:143], v[128:131]
  ds_read_b64_tr_b16 v[156:157], v27 offset:2048
  ds_read_b64_tr_b16 v[158:159], v27 offset:3072
  v_mfma_f32_16x16x32_bf16 v[132:135], a[236:239], v[140:143], v[132:135]
  global_load_dwordx4 v[240:243], v53, s[20:21] offset:-3072 sc1
  v_fma_f32 v102, v102, v17, v17
  v_fma_f32 v103, v103, v17, v17
  v_rcp_f32 v102, v102
  v_rcp_f32 v103, v103
  v_mul_f32 v104, v104, v100
  v_mul_f32 v105, v105, v101
  v_mul_f32 v106, v106, v102
  v_mul_f32 v107, v107, v103
  v_cvt_pk_bf16_f32 v20, v104, v105
  v_cvt_pk_bf16_f32 v21, v106, v107
  v_permlane16_swap_b32 v96, v108
  v_permlane16_swap_b32 v97, v109
  v_permlane16_swap_b32 v98, v110
  v_permlane16_swap_b32 v99, v111
  v_permlane16_swap_b32 v18, v20
  v_permlane16_swap_b32 v19, v21
  buffer_store_dwordx4 v[18:21], v34, s[20:23], s18 offen sc1
  v_fmac_f32 v96, v9, v64
  v_fmac_f32 v97, v9, v65
  v_fmac_f32 v98, v9, v66
  v_fmac_f32 v99, v9, v67
  v_fmac_f32 v108, v9, v68
  v_fmac_f32 v109, v9, v69
  v_fmac_f32 v110, v9, v70
  v_fmac_f32 v111, v9, v71
  v_mul_f32 v108, v96, v108
  v_mul_f32 v109, v97, v109
  v_mul_f32 v110, v98, v110
  v_mul_f32 v111, v99, v111
  v_mul_f32 v96, v96, v10
  v_mul_f32 v97, v97, v10
  v_mul_f32 v98, v98, v10
  v_mul_f32 v99, v99, v10
  v_exp_f32 v96, v96
  v_exp_f32 v97, v97
  v_exp_f32 v98, v98
  ds_read2st64_b32 v[18:19], v39 offset0:40 offset1:42
  ds_read2st64_b32 v[20:21], v39 offset0:44 offset1:46
  ds_read2st64_b32 v[22:23], v38 offset0:40 offset1:48
  ds_read2st64_b32 v[24:25], v38 offset0:56 offset1:64
  v_exp_f32 v99, v99
  v_fma_f32 v96, v96, v11, v11
  v_fma_f32 v97, v97, v11, v11
  v_fma_f32 v98, v98, v11, v11
  v_fma_f32 v99, v99, v11, v11
  v_rcp_f32 v96, v96
  v_rcp_f32 v97, v97
  v_rcp_f32 v98, v98
  v_rcp_f32 v99, v99
  v_mul_f32 v108, v108, v96
  v_mul_f32 v109, v109, v97
  v_mul_f32 v110, v110, v98
  v_mul_f32 v111, v111, v99
  v_cvt_pk_bf16_f32 v54, v108, v109
  v_cvt_pk_bf16_f32 v55, v110, v111
  buffer_store_dwordx2 v[54:55], v35, s[20:23], s18 offen sc1
  s_waitcnt lgkmcnt(0)
  s_add_u32 s18, s18, 98304
  v_add_f32 v18, v18, v19
  v_add_f32 v20, v20, v21
  v_add_f32 v22, v22, v23
  v_add_f32 v24, v24, v25
  v_add_f32 v18, v18, v20
  v_add_f32 v22, v22, v24
  v_mul_f32 v9, -0.0015625, v18
  v_mul_f32 v11, 0.0015625, v22
  v_fma_f32 v11, -v9, v9, v11
  v_max_f32 v11, 0, v11
  v_add_f32 v11, 1e-05, v11
  v_rsq_f32 v10, v11
  v_mov_b32 v12, v9
  v_mul_f32 v10, -1.4426950408889634, v10
  v_mov_b32 v15, v9
  v_mov_b32 v14, v11
  v_mov_b32 v17, v11
  v_mov_b32 v13, v10
  v_mov_b32 v16, v10
  v_permlane16_swap_b32 v12, v15
  v_permlane16_swap_b32 v14, v17
  v_permlane16_swap_b32 v13, v16
  v_mfma_f32_16x16x32_bf16 v[72:75], v[44:47], v[144:147], 0
  s_waitcnt vmcnt(14)
  ds_read_b64_tr_b16 v[136:137], v26 offset:4096
  ds_read_b64_tr_b16 v[138:139], v26 offset:5120
  v_mfma_f32_16x16x32_bf16 v[80:83], v[144:147], v[144:147], 0
  ds_read_b64_tr_b16 v[140:141], v27 offset:4096
  ds_read_b64_tr_b16 v[142:143], v27 offset:5120
  v_mfma_f32_16x16x32_bf16 v[88:91], a[0:3], v[144:147], 0
  v_mfma_f32_16x16x32_bf16 v[92:95], a[4:7], v[144:147], 0
  v_fmac_f32 v112, v12, v56
  v_fmac_f32 v113, v12, v57
  v_mfma_f32_16x16x32_bf16 v[96:99], a[8:11], v[144:147], 0
  global_load_dwordx4 v[244:247], v53, s[20:21] offset:-2048 sc1
  v_fmac_f32 v114, v12, v58
  v_mfma_f32_16x16x32_bf16 v[76:79], v[44:47], v[148:151], 0
  v_fmac_f32 v115, v12, v59
  v_fmac_f32 v116, v12, v60
  v_mfma_f32_16x16x32_bf16 v[84:87], v[148:151], v[148:151], 0
  v_fmac_f32 v117, v12, v61
  v_fmac_f32 v118, v12, v62
  v_mfma_f32_16x16x32_bf16 v[100:103], a[0:3], v[148:151], 0
  v_fmac_f32 v119, v12, v63
  v_mul_f32 v116, v112, v116
  v_mfma_f32_16x16x32_bf16 v[104:107], a[4:7], v[148:151], 0
  v_mul_f32 v117, v113, v117
  v_mul_f32 v118, v114, v118
  v_mfma_f32_16x16x32_bf16 v[108:111], a[8:11], v[148:151], 0
  global_load_dwordx4 v[248:251], v53, s[20:21] offset:-1024 sc1
  v_mul_f32 v119, v115, v119
  v_mfma_f32_16x16x32_bf16 v[72:75], v[44:47], v[152:155], v[72:75]
  s_waitcnt vmcnt(14)
  ds_read_b64_tr_b16 v[144:145], v26 offset:6144
  ds_read_b64_tr_b16 v[146:147], v26 offset:7168
  v_mfma_f32_16x16x32_bf16 v[80:83], v[152:155], v[152:155], v[80:83]
  ds_read_b64_tr_b16 v[148:149], v27 offset:6144
  ds_read_b64_tr_b16 v[150:151], v27 offset:7168
  v_mfma_f32_16x16x32_bf16 v[88:91], a[12:15], v[152:155], v[88:91]
  v_mul_f32 v112, v112, v13
  v_mul_f32 v113, v113, v13
  v_mfma_f32_16x16x32_bf16 v[92:95], a[16:19], v[152:155], v[92:95]
  v_exp_f32 v112, v112
  v_mfma_f32_16x16x32_bf16 v[96:99], a[20:23], v[152:155], v[96:99]
  global_load_dwordx4 v[252:255], v53, s[20:21] offset:0 sc1
  v_mul_f32 v114, v114, v13
  v_mfma_f32_16x16x32_bf16 v[76:79], v[44:47], v[156:159], v[76:79]
  v_exp_f32 v113, v113
  v_mfma_f32_16x16x32_bf16 v[84:87], v[156:159], v[156:159], v[84:87]
  v_exp_f32 v114, v114
  v_mfma_f32_16x16x32_bf16 v[100:103], a[12:15], v[156:159], v[100:103]
  v_mul_f32 v115, v115, v13
  v_fma_f32 v112, v112, v14, v14
  v_mfma_f32_16x16x32_bf16 v[104:107], a[16:19], v[156:159], v[104:107]
  v_exp_f32 v115, v115
  v_mfma_f32_16x16x32_bf16 v[108:111], a[20:23], v[156:159], v[108:111]
  s_waitcnt lgkmcnt(6)
  global_load_dwordx4 v[160:163], v53, s[20:21] offset:1024 sc1
  v_fma_f32 v113, v113, v14, v14
  v_mfma_f32_16x16x32_bf16 v[72:75], v[44:47], v[136:139], v[72:75]
  s_waitcnt vmcnt(14)
  v_rcp_f32 v112, v112
  v_mfma_f32_16x16x32_bf16 v[80:83], v[136:139], v[136:139], v[80:83]
  v_rcp_f32 v113, v113
  v_mfma_f32_16x16x32_bf16 v[88:91], a[24:27], v[136:139], v[88:91]
  ds_read_b64_tr_b16 v[152:153], v26 offset:8192
  ds_read_b64_tr_b16 v[154:155], v26 offset:9216
  v_mfma_f32_16x16x32_bf16 v[92:95], a[28:31], v[136:139], v[92:95]
  ds_read_b64_tr_b16 v[156:157], v27 offset:8192
  ds_read_b64_tr_b16 v[158:159], v27 offset:9216
  v_mfma_f32_16x16x32_bf16 v[96:99], a[32:35], v[136:139], v[96:99]
  s_waitcnt lgkmcnt(8)
  global_load_dwordx4 v[164:167], v53, s[20:21] offset:2048 sc1
  v_fma_f32 v114, v114, v14, v14
  v_mfma_f32_16x16x32_bf16 v[76:79], v[44:47], v[140:143], v[76:79]
  v_rcp_f32 v114, v114
  v_mfma_f32_16x16x32_bf16 v[84:87], v[140:143], v[140:143], v[84:87]
  v_fma_f32 v115, v115, v14, v14
  v_mul_f32 v116, v116, v112
  v_mfma_f32_16x16x32_bf16 v[100:103], a[24:27], v[140:143], v[100:103]
  v_rcp_f32 v115, v115
  v_mfma_f32_16x16x32_bf16 v[104:107], a[28:31], v[140:143], v[104:107]
  v_mul_f32 v117, v117, v113
  v_mul_f32 v118, v118, v114
  v_mfma_f32_16x16x32_bf16 v[108:111], a[32:35], v[140:143], v[108:111]
  s_waitcnt lgkmcnt(6)
  global_load_dwordx4 v[168:171], v53, s[20:21] offset:3072 sc1
  v_mul_f32 v119, v119, v115
  v_mfma_f32_16x16x32_bf16 v[72:75], v[44:47], v[144:147], v[72:75]
  s_barrier
  ds_read_b64_tr_b16 v[136:137], v28 offset:0
  ds_read_b64_tr_b16 v[138:139], v28 offset:1024
  v_mfma_f32_16x16x32_bf16 v[80:83], v[144:147], v[144:147], v[80:83]
  ds_read_b64_tr_b16 v[140:141], v29 offset:0
  ds_read_b64_tr_b16 v[142:143], v29 offset:1024
  v_mfma_f32_16x16x32_bf16 v[88:91], a[36:39], v[144:147], v[88:91]
  v_cvt_pk_bf16_f32 v18, v116, v117
  v_cvt_pk_bf16_f32 v19, v118, v119
  v_mfma_f32_16x16x32_bf16 v[92:95], a[40:43], v[144:147], v[92:95]
  v_fmac_f32 v124, v15, v56
  v_fmac_f32 v125, v15, v57
  v_mfma_f32_16x16x32_bf16 v[96:99], a[44:47], v[144:147], v[96:99]
  s_waitcnt lgkmcnt(8)
  v_add_u32 v53, 8192, v53
  global_load_dwordx4 v[172:175], v53, s[20:21] offset:-4096 sc1
  v_mfma_f32_16x16x32_bf16 v[76:79], v[44:47], v[148:151], v[76:79]
  v_fmac_f32 v126, v15, v58
  v_fmac_f32 v127, v15, v59
  v_mfma_f32_16x16x32_bf16 v[84:87], v[148:151], v[148:151], v[84:87]
  v_fmac_f32 v128, v15, v60
  v_fmac_f32 v129, v15, v61
  v_mfma_f32_16x16x32_bf16 v[100:103], a[36:39], v[148:151], v[100:103]
  v_fmac_f32 v130, v15, v62
  v_fmac_f32 v131, v15, v63
  v_mfma_f32_16x16x32_bf16 v[104:107], a[40:43], v[148:151], v[104:107]
  v_mul_f32 v128, v124, v128
  v_mul_f32 v129, v125, v129
  v_mfma_f32_16x16x32_bf16 v[108:111], a[44:47], v[148:151], v[108:111]
  s_waitcnt lgkmcnt(6)
  global_load_dwordx4 v[176:179], v53, s[20:21] offset:-3072 sc1
  v_mul_f32 v130, v126, v130
  v_mfma_f32_16x16x32_bf16 v[72:75], v[44:47], v[152:155], v[72:75]
  ds_read_b64_tr_b16 v[144:145], v28 offset:2048
  ds_read_b64_tr_b16 v[146:147], v28 offset:3072
  v_mfma_f32_16x16x32_bf16 v[80:83], v[152:155], v[152:155], v[80:83]
  ds_read_b64_tr_b16 v[148:149], v29 offset:2048
  ds_read_b64_tr_b16 v[150:151], v29 offset:3072
  v_mfma_f32_16x16x32_bf16 v[88:91], a[48:51], v[152:155], v[88:91]
  v_mul_f32 v131, v127, v131
  v_mul_f32 v124, v124, v16
  v_mfma_f32_16x16x32_bf16 v[92:95], a[52:55], v[152:155], v[92:95]
  v_exp_f32 v124, v124
  v_mfma_f32_16x16x32_bf16 v[96:99], a[56:59], v[152:155], v[96:99]
  s_waitcnt lgkmcnt(8)
  s_add_u32 m0, s17, 40960
  v_add_u32 v0, 32896, v0
  global_load_lds_dwordx4 v0, s[20:21] offset:0 sc1
  v_mfma_f32_16x16x32_bf16 v[76:79], v[44:47], v[156:159], v[76:79]
  v_mul_f32 v125, v125, v16
  v_mul_f32 v126, v126, v16
  v_mfma_f32_16x16x32_bf16 v[84:87], v[156:159], v[156:159], v[84:87]
  v_exp_f32 v125, v125
  v_mfma_f32_16x16x32_bf16 v[100:103], a[48:51], v[156:159], v[100:103]
  v_exp_f32 v126, v126
  v_mfma_f32_16x16x32_bf16 v[104:107], a[52:55], v[156:159], v[104:107]
  v_mul_f32 v127, v127, v16
  v_fma_f32 v124, v124, v17, v17
  v_mfma_f32_16x16x32_bf16 v[108:111], a[56:59], v[156:159], v[108:111]
  s_waitcnt lgkmcnt(6)
  global_load_lds_dwordx4 v0, s[20:21] offset:1024 sc1
  v_fma_f32 v125, v125, v17, v17
  v_mfma_f32_16x16x32_bf16 v[88:91], a[60:63], v[136:139], v[88:91]
  v_exp_f32 v127, v127
  v_mfma_f32_16x16x32_bf16 v[92:95], a[64:67], v[136:139], v[92:95]
  v_rcp_f32 v124, v124
  v_mfma_f32_16x16x32_bf16 v[96:99], a[68:71], v[136:139], v[96:99]
  s_waitcnt lgkmcnt(4)
  v_mov_b32 v3, 1
  ds_read_b64_tr_b16 v[152:153], v28 offset:4096
  v_mfma_f32_16x16x32_bf16 v[100:103], a[60:63], v[140:143], v[100:103]
  s_waitcnt vmcnt(10)
  buffer_store_dword v3, v40, s[20:23], 0 offen sc1
  v_mfma_f32_16x16x32_bf16 v[104:107], a[64:67], v[140:143], v[104:107]
  global_load_lds_dwordx4 v0, s[20:21] offset:2048 sc1
  ds_read_b64_tr_b16 v[154:155], v28 offset:5120
  v_mfma_f32_16x16x32_bf16 v[108:111], a[68:71], v[140:143], v[108:111]
  s_waitcnt lgkmcnt(4)
  ds_read_b64_tr_b16 v[156:157], v29 offset:4096
  ds_read_b64_tr_b16 v[158:159], v29 offset:5120
  v_mfma_f32_16x16x32_bf16 v[88:91], a[72:75], v[144:147], v[88:91]
  v_rcp_f32 v125, v125
  v_mfma_f32_16x16x32_bf16 v[92:95], a[76:79], v[144:147], v[92:95]
  ds_write_b64 v36, v[80:81] offset:0
  v_mfma_f32_16x16x32_bf16 v[96:99], a[80:83], v[144:147], v[96:99]
  s_waitcnt lgkmcnt(5)
  ds_write_b64 v36, v[82:83] offset:8
  v_mfma_f32_16x16x32_bf16 v[100:103], a[72:75], v[148:151], v[100:103]
  global_load_lds_dwordx4 v0, s[20:21] offset:3072 sc1
  ds_read_b64_tr_b16 v[136:137], v28 offset:6144
  v_mfma_f32_16x16x32_bf16 v[104:107], a[76:79], v[148:151], v[104:107]
  ds_read_b64_tr_b16 v[138:139], v28 offset:7168
  ds_read_b64_tr_b16 v[140:141], v29 offset:6144
  v_mfma_f32_16x16x32_bf16 v[108:111], a[80:83], v[148:151], v[108:111]
  s_waitcnt lgkmcnt(7)
  ds_read_b64_tr_b16 v[142:143], v29 offset:7168
  v_fma_f32 v126, v126, v17, v17
  v_mfma_f32_16x16x32_bf16 v[88:91], a[84:87], v[152:155], v[88:91]
  ds_write_b32 v37, v72 offset:0
  v_mfma_f32_16x16x32_bf16 v[92:95], a[88:91], v[152:155], v[92:95]
  v_rcp_f32 v126, v126
  v_mfma_f32_16x16x32_bf16 v[96:99], a[92:95], v[152:155], v[96:99]
  s_waitcnt lgkmcnt(7)
  s_add_u32 m0, s17, 45056
  v_add_u32 v0, 4096, v0
  global_load_lds_dwordx4 v0, s[20:21] offset:0 sc1
  v_mfma_f32_16x16x32_bf16 v[100:103], a[84:87], v[156:159], v[100:103]
  ds_write_b64 v36, v[84:85] offset:1024
  v_mfma_f32_16x16x32_bf16 v[104:107], a[88:91], v[156:159], v[104:107]
  ds_read_b64_tr_b16 v[144:145], v28 offset:8192
  ds_read_b64_tr_b16 v[146:147], v28 offset:9216
  v_mfma_f32_16x16x32_bf16 v[108:111], a[92:95], v[156:159], v[108:111]
  s_waitcnt lgkmcnt(6)
  ds_write_b64 v36, v[86:87] offset:1032
  ds_read_b64_tr_b16 v[148:149], v29 offset:8192
  ds_read_b64_tr_b16 v[150:151], v29 offset:9216
  v_mfma_f32_16x16x32_bf16 v[88:91], a[96:99], v[136:139], v[88:91]
  ds_write_b32 v37, v76 offset:256
  v_mfma_f32_16x16x32_bf16 v[92:95], a[100:103], v[136:139], v[92:95]
  global_load_lds_dwordx4 v0, s[20:21] offset:1024 sc1
  ds_read_b64_tr_b16 v[152:153], v30 offset:0
  v_mfma_f32_16x16x32_bf16 v[96:99], a[104:107], v[136:139], v[96:99]
  s_waitcnt lgkmcnt(9)
  ds_read_b64_tr_b16 v[154:155], v30 offset:1024
  ds_read_b64_tr_b16 v[156:157], v31 offset:0
  v_mfma_f32_16x16x32_bf16 v[100:103], a[96:99], v[140:143], v[100:103]
  ds_read_b64_tr_b16 v[158:159], v31 offset:1024
  v_fma_f32 v127, v127, v17, v17
  v_mfma_f32_16x16x32_bf16 v[104:107], a[100:103], v[140:143], v[104:107]
  v_rcp_f32 v127, v127
  v_mfma_f32_16x16x32_bf16 v[108:111], a[104:107], v[140:143], v[108:111]
  s_waitcnt lgkmcnt(8)
  v_mul_f32 v128, v128, v124
  v_mul_f32 v129, v129, v125
  v_mfma_f32_16x16x32_bf16 v[88:91], a[108:111], v[144:147], v[88:91]
  global_load_lds_dwordx4 v0, s[20:21] offset:2048 sc1
  ds_read_b64_tr_b16 v[136:137], v30 offset:2048
  v_mfma_f32_16x16x32_bf16 v[92:95], a[112:115], v[144:147], v[92:95]
  ds_read_b64_tr_b16 v[138:139], v30 offset:3072
  ds_read_b64_tr_b16 v[140:141], v31 offset:2048
  v_mfma_f32_16x16x32_bf16 v[96:99], a[116:119], v[144:147], v[96:99]
  s_waitcnt lgkmcnt(8)
  ds_read_b64_tr_b16 v[142:143], v31 offset:3072
  v_mul_f32 v130, v130, v126
  v_mfma_f32_16x16x32_bf16 v[100:103], a[108:111], v[148:151], v[100:103]
  v_mul_f32 v131, v131, v127
  v_cvt_pk_bf16_f32 v20, v128, v129
  v_mfma_f32_16x16x32_bf16 v[104:107], a[112:115], v[148:151], v[104:107]
  v_cvt_pk_bf16_f32 v21, v130, v131
  v_permlane16_swap_b32 v120, v132
  v_mfma_f32_16x16x32_bf16 v[108:111], a[116:119], v[148:151], v[108:111]
  s_waitcnt lgkmcnt(6)
  global_load_lds_dwordx4 v0, s[20:21] offset:3072 sc1
  v_permlane16_swap_b32 v121, v133
  v_mfma_f32_16x16x32_bf16 v[88:91], a[120:123], v[152:155], v[88:91]
  ds_read_b64_tr_b16 v[144:145], v30 offset:4096
  ds_read_b64_tr_b16 v[146:147], v30 offset:5120
  v_mfma_f32_16x16x32_bf16 v[92:95], a[124:127], v[152:155], v[92:95]
  ds_read_b64_tr_b16 v[148:149], v31 offset:4096
  ds_read_b64_tr_b16 v[150:151], v31 offset:5120
  v_mfma_f32_16x16x32_bf16 v[96:99], a[128:131], v[152:155], v[96:99]
  s_waitcnt lgkmcnt(8)
  v_permlane16_swap_b32 v122, v134
  v_permlane16_swap_b32 v123, v135
  v_mfma_f32_16x16x32_bf16 v[100:103], a[120:123], v[156:159], v[100:103]
  v_permlane16_swap_b32 v18, v20
  v_permlane16_swap_b32 v19, v21
  v_mfma_f32_16x16x32_bf16 v[104:107], a[124:127], v[156:159], v[104:107]
  s_barrier
  s_add_u32 m0, s17, 49152
  v_add_u32 v0, 4096, v0
  global_load_lds_dwordx4 v0, s[20:21] offset:0 sc1
  v_mfma_f32_16x16x32_bf16 v[108:111], a[128:131], v[156:159], v[108:111]
  s_waitcnt lgkmcnt(6)
  buffer_store_dwordx4 v[18:21], v34, s[20:23], s18 offen sc1
  v_mfma_f32_16x16x32_bf16 v[88:91], a[132:135], v[136:139], v[88:91]
  ds_read_b64_tr_b16 v[152:153], v30 offset:6144
  ds_read_b64_tr_b16 v[154:155], v30 offset:7168
  v_mfma_f32_16x16x32_bf16 v[92:95], a[136:139], v[136:139], v[92:95]
  ds_read_b64_tr_b16 v[156:157], v31 offset:6144
  ds_read_b64_tr_b16 v[158:159], v31 offset:7168
  v_mfma_f32_16x16x32_bf16 v[96:99], a[140:143], v[136:139], v[96:99]
  s_waitcnt lgkmcnt(8)
  v_fmac_f32 v120, v9, v64
  v_fmac_f32 v121, v9, v65
  v_mfma_f32_16x16x32_bf16 v[100:103], a[132:135], v[140:143], v[100:103]
  global_load_lds_dwordx4 v0, s[20:21] offset:1024 sc1
  v_fmac_f32 v122, v9, v66
  v_mfma_f32_16x16x32_bf16 v[104:107], a[136:139], v[140:143], v[104:107]
  v_fmac_f32 v123, v9, v67
  v_fmac_f32 v132, v9, v68
  v_mfma_f32_16x16x32_bf16 v[108:111], a[140:143], v[140:143], v[108:111]
  s_waitcnt lgkmcnt(6)
  v_fmac_f32 v133, v9, v69
  v_fmac_f32 v134, v9, v70
  v_mfma_f32_16x16x32_bf16 v[88:91], a[144:147], v[144:147], v[88:91]
  ds_read_b64_tr_b16 v[136:137], v30 offset:8192
  ds_read_b64_tr_b16 v[138:139], v30 offset:9216
  v_mfma_f32_16x16x32_bf16 v[92:95], a[148:151], v[144:147], v[92:95]
  ds_read_b64_tr_b16 v[140:141], v31 offset:8192
  ds_read_b64_tr_b16 v[142:143], v31 offset:9216
  v_mfma_f32_16x16x32_bf16 v[96:99], a[152:155], v[144:147], v[96:99]
  s_waitcnt lgkmcnt(8)
  global_load_dwordx4 v[180:183], v53, s[20:21] offset:-2048 sc1
  v_fmac_f32 v135, v9, v71
  v_mfma_f32_16x16x32_bf16 v[100:103], a[144:147], v[148:151], v[100:103]
  v_mul_f32 v132, v120, v132
  v_mul_f32 v133, v121, v133
  v_mfma_f32_16x16x32_bf16 v[104:107], a[148:151], v[148:151], v[104:107]
  v_mul_f32 v134, v122, v134
  v_mul_f32 v135, v123, v135
  v_mfma_f32_16x16x32_bf16 v[108:111], a[152:155], v[148:151], v[108:111]
  s_waitcnt lgkmcnt(6)
  v_mul_f32 v120, v120, v10
  v_mul_f32 v121, v121, v10
  v_mfma_f32_16x16x32_bf16 v[88:91], a[156:159], v[152:155], v[88:91]
  v_exp_f32 v120, v120
  v_mfma_f32_16x16x32_bf16 v[92:95], a[160:163], v[152:155], v[92:95]
  global_load_dwordx4 v[184:187], v53, s[20:21] offset:-1024 sc1
  ds_read_b64_tr_b16 v[144:145], v32 offset:0
  v_mfma_f32_16x16x32_bf16 v[96:99], a[164:167], v[152:155], v[96:99]
  s_waitcnt lgkmcnt(5)
  v_exp_f32 v121, v121
  v_mfma_f32_16x16x32_bf16 v[100:103], a[156:159], v[156:159], v[100:103]
  ds_read_b64_tr_b16 v[146:147], v32 offset:1024
  ds_read_b64_tr_b16 v[148:149], v33 offset:0
  v_mfma_f32_16x16x32_bf16 v[104:107], a[160:163], v[156:159], v[104:107]
  ds_read_b64_tr_b16 v[150:151], v33 offset:1024
  v_mul_f32 v122, v122, v10
  v_mfma_f32_16x16x32_bf16 v[108:111], a[164:167], v[156:159], v[108:111]
  s_waitcnt lgkmcnt(6)
  v_exp_f32 v122, v122
  v_mfma_f32_16x16x32_bf16 v[88:91], a[168:171], v[136:139], v[88:91]
  global_load_dwordx4 a[240:243], v53, s[20:21] offset:0 sc1
  ds_read_b64_tr_b16 v[152:153], v32 offset:2048
  v_mfma_f32_16x16x32_bf16 v[92:95], a[172:175], v[136:139], v[92:95]
  ds_read_b64_tr_b16 v[154:155], v32 offset:3072
  ds_read_b64_tr_b16 v[156:157], v33 offset:2048
  v_mfma_f32_16x16x32_bf16 v[96:99], a[176:179], v[136:139], v[96:99]
  s_waitcnt lgkmcnt(7)
  ds_read_b64_tr_b16 v[158:159], v33 offset:3072
  v_mul_f32 v123, v123, v10
  v_mfma_f32_16x16x32_bf16 v[100:103], a[168:171], v[140:143], v[100:103]
  v_exp_f32 v123, v123
  v_mfma_f32_16x16x32_bf16 v[104:107], a[172:175], v[140:143], v[104:107]
  ds_read2st64_b32 v[18:19], v39 offset0:0 offset1:2
  ds_read2st64_b32 v[20:21], v39 offset0:4 offset1:6
  v_mfma_f32_16x16x32_bf16 v[108:111], a[176:179], v[140:143], v[108:111]
  s_waitcnt lgkmcnt(8)
  global_load_dwordx4 a[244:247], v53, s[20:21] offset:1024 sc1
  ds_read2st64_b32 v[22:23], v38 offset0:0 offset1:8
  v_mfma_f32_16x16x32_bf16 v[88:91], a[180:183], v[144:147], v[88:91]
  ds_read_b64_tr_b16 v[136:137], v32 offset:4096
  ds_read_b64_tr_b16 v[138:139], v32 offset:5120
  v_mfma_f32_16x16x32_bf16 v[92:95], a[184:187], v[144:147], v[92:95]
  ds_read_b64_tr_b16 v[140:141], v33 offset:4096
  ds_read_b64_tr_b16 v[142:143], v33 offset:5120
  v_mfma_f32_16x16x32_bf16 v[96:99], a[188:191], v[144:147], v[96:99]
  s_waitcnt lgkmcnt(11)
  ds_read2st64_b32 v[24:25], v38 offset0:16 offset1:24
  v_fma_f32 v120, v120, v11, v11
  v_mfma_f32_16x16x32_bf16 v[100:103], a[180:183], v[148:151], v[100:103]
  v_rcp_f32 v120, v120
  v_mfma_f32_16x16x32_bf16 v[104:107], a[184:187], v[148:151], v[104:107]
  global_load_dwordx4 a[248:251], v53, s[20:21] offset:2048 sc1
  v_fma_f32 v121, v121, v11, v11
  v_mfma_f32_16x16x32_bf16 v[108:111], a[188:191], v[148:151], v[108:111]
  s_waitcnt lgkmcnt(10)
  v_rcp_f32 v121, v121
  v_mfma_f32_16x16x32_bf16 v[88:91], a[192:195], v[152:155], v[88:91]
  buffer_load_dword v8, v41, s[20:23], 0 offen sc1
  v_mfma_f32_16x16x32_bf16 v[92:95], a[196:199], v[152:155], v[92:95]
  ds_read_b64_tr_b16 v[144:145], v32 offset:6144
  ds_read_b64_tr_b16 v[146:147], v32 offset:7168
  v_mfma_f32_16x16x32_bf16 v[96:99], a[200:203], v[152:155], v[96:99]
  s_waitcnt lgkmcnt(10)
  ds_read_b64_tr_b16 v[148:149], v33 offset:6144
  ds_read_b64_tr_b16 v[150:151], v33 offset:7168
  v_mfma_f32_16x16x32_bf16 v[100:103], a[192:195], v[156:159], v[100:103]
  global_load_dwordx4 a[252:255], v53, s[20:21] offset:3072 sc1
  v_fma_f32 v122, v122, v11, v11
  v_mfma_f32_16x16x32_bf16 v[104:107], a[196:199], v[156:159], v[104:107]
  v_rcp_f32 v122, v122
  v_mfma_f32_16x16x32_bf16 v[108:111], a[200:203], v[156:159], v[108:111]
  s_waitcnt lgkmcnt(7)
  v_fma_f32 v123, v123, v11, v11
  v_mul_f32 v132, v132, v120
  v_mfma_f32_16x16x32_bf16 v[88:91], a[204:207], v[136:139], v[88:91]
  v_rcp_f32 v123, v123
  v_mfma_f32_16x16x32_bf16 v[92:95], a[208:211], v[136:139], v[92:95]
  ds_read_b64_tr_b16 v[152:153], v32 offset:8192
  ds_read_b64_tr_b16 v[154:155], v32 offset:9216
  v_mfma_f32_16x16x32_bf16 v[96:99], a[212:215], v[136:139], v[96:99]
  s_waitcnt lgkmcnt(7)
  s_add_u32 m0, s75, 0
  v_add_u32 v53, 4096, v53
  global_load_lds_dwordx4 v53, s[20:21] offset:0 sc1
  v_mfma_f32_16x16x32_bf16 v[100:103], a[204:207], v[140:143], v[100:103]
  ds_read_b64_tr_b16 v[156:157], v33 offset:8192
  ds_read_b64_tr_b16 v[158:159], v33 offset:9216
  v_mfma_f32_16x16x32_bf16 v[104:107], a[208:211], v[140:143], v[104:107]
  v_mul_f32 v133, v133, v121
  v_mul_f32 v134, v134, v122
  v_mfma_f32_16x16x32_bf16 v[108:111], a[212:215], v[140:143], v[108:111]
  s_waitcnt lgkmcnt(6)
  v_mul_f32 v135, v135, v123
  v_cvt_pk_bf16_f32 v54, v132, v133
  v_mfma_f32_16x16x32_bf16 v[88:91], a[216:219], v[144:147], v[88:91]
  s_waitcnt vmcnt(18)
  ds_read_b64_tr_b16 v[136:137], v26 offset:40960
  ds_read_b64_tr_b16 v[138:139], v26 offset:41984
  v_mfma_f32_16x16x32_bf16 v[92:95], a[220:223], v[144:147], v[92:95]
  global_load_lds_dwordx4 v53, s[20:21] offset:1024 sc1
  ds_read_b64_tr_b16 v[140:141], v27 offset:40960
  v_mfma_f32_16x16x32_bf16 v[96:99], a[224:227], v[144:147], v[96:99]
  s_waitcnt lgkmcnt(7)
  ds_read_b64_tr_b16 v[142:143], v27 offset:41984
  v_cvt_pk_bf16_f32 v55, v134, v135
  v_mfma_f32_16x16x32_bf16 v[100:103], a[216:219], v[148:151], v[100:103]
  buffer_store_dwordx2 v[54:55], v35, s[20:23], s18 offen sc1
  v_mfma_f32_16x16x32_bf16 v[104:107], a[220:223], v[148:151], v[104:107]
  s_add_u32 s18, s18, 3047424
  v_add_f32 v18, v18, v19
  v_mfma_f32_16x16x32_bf16 v[108:111], a[224:227], v[148:151], v[108:111]
  s_waitcnt lgkmcnt(6)
  v_add_f32 v20, v20, v21
  v_add_f32 v22, v22, v23
  v_mfma_f32_16x16x32_bf16 v[88:91], a[228:231], v[152:155], v[88:91]
  s_waitcnt vmcnt(17)
  global_load_lds_dwordx4 v53, s[20:21] offset:2048 sc1
  ds_read_b64_tr_b16 v[144:145], v26 offset:43008
  v_mfma_f32_16x16x32_bf16 v[92:95], a[232:235], v[152:155], v[92:95]
  ds_read_b64_tr_b16 v[146:147], v26 offset:44032
  ds_read_b64_tr_b16 v[148:149], v27 offset:43008
  v_mfma_f32_16x16x32_bf16 v[96:99], a[236:239], v[152:155], v[96:99]
  s_waitcnt lgkmcnt(7)
  ds_read_b64_tr_b16 v[150:151], v27 offset:44032
  v_add_f32 v24, v24, v25
  v_mfma_f32_16x16x32_bf16 v[100:103], a[228:231], v[156:159], v[100:103]
  v_add_f32 v18, v18, v20
  v_add_f32 v22, v22, v24
  v_mfma_f32_16x16x32_bf16 v[104:107], a[232:235], v[156:159], v[104:107]
  v_mul_f32 v9, -0.0015625, v18
  v_mul_f32 v11, 0.0015625, v22
  v_mfma_f32_16x16x32_bf16 v[108:111], a[236:239], v[156:159], v[108:111]
  global_load_lds_dwordx4 v53, s[20:21] offset:3072 sc1
  v_fma_f32 v11, -v9, v9, v11
  v_max_f32 v11, 0, v11
  v_add_f32 v11, 1e-05, v11
  v_rsq_f32 v10, v11
  v_mov_b32 v12, v9
  v_mul_f32 v10, -1.4426950408889634, v10
  v_mov_b32 v15, v9
  v_mov_b32 v14, v11
  v_mov_b32 v17, v11
  v_mov_b32 v13, v10
  v_mov_b32 v16, v10
  v_permlane16_swap_b32 v12, v15
  v_permlane16_swap_b32 v14, v17
  v_permlane16_swap_b32 v13, v16
  s_waitcnt lgkmcnt(6)
  v_mfma_f32_16x16x32_bf16 v[72:75], v[44:47], v[136:139], 0
  s_waitcnt vmcnt(17)
  ds_read_b64_tr_b16 v[152:153], v26 offset:45056
  ds_read_b64_tr_b16 v[154:155], v26 offset:46080
  v_mfma_f32_16x16x32_bf16 v[80:83], v[136:139], v[136:139], 0
  ds_read_b64_tr_b16 v[156:157], v27 offset:45056
  ds_read_b64_tr_b16 v[158:159], v27 offset:46080
  v_mfma_f32_16x16x32_bf16 v[112:115], a[0:3], v[136:139], 0
  v_mfma_f32_16x16x32_bf16 v[116:119], a[4:7], v[136:139], 0
  v_fmac_f32 v88, v12, v56
  v_fmac_f32 v89, v12, v57
  v_mfma_f32_16x16x32_bf16 v[120:123], a[8:11], v[136:139], 0
  s_waitcnt lgkmcnt(8)
  s_add_u32 m0, s75, 4096
  v_add_u32 v53, 4096, v53
  global_load_lds_dwordx4 v53, s[20:21] offset:0 sc1
  v_mfma_f32_16x16x32_bf16 v[76:79], v[44:47], v[140:143], 0
  v_fmac_f32 v90, v12, v58
  v_fmac_f32 v91, v12, v59
  v_mfma_f32_16x16x32_bf16 v[84:87], v[140:143], v[140:143], 0
  v_fmac_f32 v92, v12, v60
  v_fmac_f32 v93, v12, v61
  v_mfma_f32_16x16x32_bf16 v[124:127], a[0:3], v[140:143], 0
  v_fmac_f32 v94, v12, v62
  v_fmac_f32 v95, v12, v63
  v_mfma_f32_16x16x32_bf16 v[128:131], a[4:7], v[140:143], 0
  v_mul_f32 v92, v88, v92
  v_mul_f32 v93, v89, v93
  v_mfma_f32_16x16x32_bf16 v[132:135], a[8:11], v[140:143], 0
  s_waitcnt lgkmcnt(6)
  global_load_lds_dwordx4 v53, s[20:21] offset:1024 sc1
  v_mul_f32 v94, v90, v94
  v_mfma_f32_16x16x32_bf16 v[72:75], v[44:47], v[144:147], v[72:75]
  s_waitcnt vmcnt(17)
  ds_read_b64_tr_b16 v[136:137], v26 offset:47104
  ds_read_b64_tr_b16 v[138:139], v26 offset:48128
  v_mfma_f32_16x16x32_bf16 v[80:83], v[144:147], v[144:147], v[80:83]
  ds_read_b64_tr_b16 v[140:141], v27 offset:47104
  ds_read_b64_tr_b16 v[142:143], v27 offset:48128
  v_mfma_f32_16x16x32_bf16 v[112:115], a[12:15], v[144:147], v[112:115]
  v_mul_f32 v95, v91, v95
  v_mul_f32 v88, v88, v13
  v_mfma_f32_16x16x32_bf16 v[116:119], a[16:19], v[144:147], v[116:119]
  v_exp_f32 v88, v88
  v_mfma_f32_16x16x32_bf16 v[120:123], a[20:23], v[144:147], v[120:123]
  s_waitcnt lgkmcnt(8)
  global_load_lds_dwordx4 v53, s[20:21] offset:2048 sc1
  v_mul_f32 v89, v89, v13
  v_mfma_f32_16x16x32_bf16 v[76:79], v[44:47], v[148:151], v[76:79]
  v_exp_f32 v89, v89
  v_mfma_f32_16x16x32_bf16 v[84:87], v[148:151], v[148:151], v[84:87]
  v_mul_f32 v90, v90, v13
  v_mul_f32 v91, v91, v13
  v_mfma_f32_16x16x32_bf16 v[124:127], a[12:15], v[148:151], v[124:127]
  v_exp_f32 v90, v90
  v_mfma_f32_16x16x32_bf16 v[128:131], a[16:19], v[148:151], v[128:131]
  v_exp_f32 v91, v91
  v_mfma_f32_16x16x32_bf16 v[132:135], a[20:23], v[148:151], v[132:135]
  s_waitcnt lgkmcnt(6)
  global_load_lds_dwordx4 v53, s[20:21] offset:3072 sc1
  v_fma_f32 v88, v88, v14, v14
  v_mfma_f32_16x16x32_bf16 v[72:75], v[44:47], v[152:155], v[72:75]
  s_waitcnt vmcnt(16)
  v_rcp_f32 v88, v88
  v_mfma_f32_16x16x32_bf16 v[80:83], v[152:155], v[152:155], v[80:83]
  ds_read_b64_tr_b16 v[144:145], v26 offset:49152
  ds_read_b64_tr_b16 v[146:147], v26 offset:50176
  v_mfma_f32_16x16x32_bf16 v[112:115], a[24:27], v[152:155], v[112:115]
  ds_read_b64_tr_b16 v[148:149], v27 offset:49152
  ds_read_b64_tr_b16 v[150:151], v27 offset:50176
  v_mfma_f32_16x16x32_bf16 v[116:119], a[28:31], v[152:155], v[116:119]
  v_fma_f32 v89, v89, v14, v14
  v_fma_f32 v90, v90, v14, v14
  v_mfma_f32_16x16x32_bf16 v[120:123], a[32:35], v[152:155], v[120:123]
  s_waitcnt lgkmcnt(8)
  s_add_u32 m0, s75, 8192
  v_add_u32 v53, 4096, v53
  global_load_lds_dwordx4 v53, s[20:21] offset:0 sc1
  v_mfma_f32_16x16x32_bf16 v[76:79], v[44:47], v[156:159], v[76:79]
  v_rcp_f32 v89, v89
  v_mfma_f32_16x16x32_bf16 v[84:87], v[156:159], v[156:159], v[84:87]
  v_rcp_f32 v90, v90
  v_mfma_f32_16x16x32_bf16 v[124:127], a[24:27], v[156:159], v[124:127]
  v_fma_f32 v91, v91, v14, v14
  v_mul_f32 v92, v92, v88
  v_mfma_f32_16x16x32_bf16 v[128:131], a[28:31], v[156:159], v[128:131]
  v_rcp_f32 v91, v91
  v_mfma_f32_16x16x32_bf16 v[132:135], a[32:35], v[156:159], v[132:135]
  s_waitcnt lgkmcnt(6)
  global_load_lds_dwordx4 v53, s[20:21] offset:1024 sc1
  v_mul_f32 v93, v93, v89
  v_mfma_f32_16x16x32_bf16 v[72:75], v[44:47], v[136:139], v[72:75]
  s_barrier
  ds_read_b64_tr_b16 v[152:153], v28 offset:40960
  ds_read_b64_tr_b16 v[154:155], v28 offset:41984
  v_mfma_f32_16x16x32_bf16 v[80:83], v[136:139], v[136:139], v[80:83]
  ds_read_b64_tr_b16 v[156:157], v29 offset:40960
  ds_read_b64_tr_b16 v[158:159], v29 offset:41984
  v_mfma_f32_16x16x32_bf16 v[112:115], a[36:39], v[136:139], v[112:115]
  v_mul_f32 v94, v94, v90
  v_mul_f32 v95, v95, v91
  v_mfma_f32_16x16x32_bf16 v[116:119], a[40:43], v[136:139], v[116:119]
  v_cvt_pk_bf16_f32 v18, v92, v93
  v_cvt_pk_bf16_f32 v19, v94, v95
  v_mfma_f32_16x16x32_bf16 v[120:123], a[44:47], v[136:139], v[120:123]
  s_waitcnt lgkmcnt(8)
  global_load_lds_dwordx4 v53, s[20:21] offset:2048 sc1
  v_fmac_f32 v100, v15, v56
  v_mfma_f32_16x16x32_bf16 v[76:79], v[44:47], v[140:143], v[76:79]
  v_fmac_f32 v101, v15, v57
  v_fmac_f32 v102, v15, v58
  v_mfma_f32_16x16x32_bf16 v[84:87], v[140:143], v[140:143], v[84:87]
  v_fmac_f32 v103, v15, v59
  v_fmac_f32 v104, v15, v60
  v_mfma_f32_16x16x32_bf16 v[124:127], a[36:39], v[140:143], v[124:127]
  v_fmac_f32 v105, v15, v61
  v_fmac_f32 v106, v15, v62
  v_mfma_f32_16x16x32_bf16 v[128:131], a[40:43], v[140:143], v[128:131]
  v_fmac_f32 v107, v15, v63
  v_mul_f32 v104, v100, v104
  v_mfma_f32_16x16x32_bf16 v[132:135], a[44:47], v[140:143], v[132:135]
  s_waitcnt lgkmcnt(6)
  global_load_lds_dwordx4 v53, s[20:21] offset:3072 sc1
  v_mul_f32 v105, v101, v105
  v_mfma_f32_16x16x32_bf16 v[72:75], v[44:47], v[144:147], v[72:75]
  s_waitcnt vmcnt(14)
  v_cmp_gt_u32 vcc, 1, v8
  s_cbranch_vccnz slow_21
back_22:
  v_mfma_f32_16x16x32_bf16 v[80:83], v[144:147], v[144:147], v[80:83]
  ds_read_b64_tr_b16 v[136:137], v28 offset:43008
  ds_read_b64_tr_b16 v[138:139], v28 offset:44032
  v_mfma_f32_16x16x32_bf16 v[112:115], a[48:51], v[144:147], v[112:115]
  ds_read_b64_tr_b16 v[140:141], v29 offset:43008
  ds_read_b64_tr_b16 v[142:143], v29 offset:44032
  v_mfma_f32_16x16x32_bf16 v[116:119], a[52:55], v[144:147], v[116:119]
  v_mul_f32 v106, v102, v106
  v_mul_f32 v107, v103, v107
  v_mfma_f32_16x16x32_bf16 v[120:123], a[56:59], v[144:147], v[120:123]
  s_waitcnt lgkmcnt(8)
  s_add_u32 m0, s75, 12288
  v_add_u32 v53, 4096, v53
  global_load_lds_dwordx4 v53, s[20:21] offset:0 sc1
  v_mfma_f32_16x16x32_bf16 v[76:79], v[44:47], v[148:151], v[76:79]
  v_mul_f32 v100, v100, v16
  v_mul_f32 v101, v101, v16
  v_mfma_f32_16x16x32_bf16 v[84:87], v[148:151], v[148:151], v[84:87]
  v_exp_f32 v100, v100
  v_mfma_f32_16x16x32_bf16 v[124:127], a[48:51], v[148:151], v[124:127]
  v_exp_f32 v101, v101
  v_mfma_f32_16x16x32_bf16 v[128:131], a[52:55], v[148:151], v[128:131]
  v_mul_f32 v102, v102, v16
  v_mul_f32 v103, v103, v16
  v_mfma_f32_16x16x32_bf16 v[132:135], a[56:59], v[148:151], v[132:135]
  s_waitcnt lgkmcnt(6)
  global_load_lds_dwordx4 v53, s[20:21] offset:1024 sc1
  v_fma_f32 v100, v100, v17, v17
  v_mfma_f32_16x16x32_bf16 v[112:115], a[60:63], v[152:155], v[112:115]
  v_exp_f32 v102, v102
  v_mfma_f32_16x16x32_bf16 v[116:119], a[64:67], v[152:155], v[116:119]
  v_exp_f32 v103, v103
  v_mfma_f32_16x16x32_bf16 v[120:123], a[68:71], v[152:155], v[120:123]
  s_waitcnt lgkmcnt(4)
  v_mov_b32 v3, 2
  ds_read_b64_tr_b16 v[144:145], v28 offset:45056
  v_mfma_f32_16x16x32_bf16 v[124:127], a[60:63], v[156:159], v[124:127]
  s_waitcnt vmcnt(12)
  buffer_store_dword v3, v40, s[20:23], 0 offen sc1
  v_mfma_f32_16x16x32_bf16 v[128:131], a[64:67], v[156:159], v[128:131]
  global_load_lds_dwordx4 v53, s[20:21] offset:2048 sc1
  ds_read_b64_tr_b16 v[146:147], v28 offset:46080
  v_mfma_f32_16x16x32_bf16 v[132:135], a[68:71], v[156:159], v[132:135]
  s_waitcnt lgkmcnt(4)
  ds_read_b64_tr_b16 v[148:149], v29 offset:45056
  ds_read_b64_tr_b16 v[150:151], v29 offset:46080
  v_mfma_f32_16x16x32_bf16 v[112:115], a[72:75], v[136:139], v[112:115]
  v_rcp_f32 v100, v100
  v_mfma_f32_16x16x32_bf16 v[116:119], a[76:79], v[136:139], v[116:119]
  ds_write_b64 v36, v[80:81] offset:0
  v_mfma_f32_16x16x32_bf16 v[120:123], a[80:83], v[136:139], v[120:123]
  s_waitcnt lgkmcnt(5)
  ds_write_b64 v36, v[82:83] offset:8
  v_mfma_f32_16x16x32_bf16 v[124:127], a[72:75], v[140:143], v[124:127]
  global_load_dwordx4 a[0:3], v2, s[20:21] offset:0 sc1
  ds_read_b64_tr_b16 v[152:153], v28 offset:47104
  v_mfma_f32_16x16x32_bf16 v[128:131], a[76:79], v[140:143], v[128:131]
  ds_read_b64_tr_b16 v[154:155], v28 offset:48128
  ds_read_b64_tr_b16 v[156:157], v29 offset:47104
  v_mfma_f32_16x16x32_bf16 v[132:135], a[80:83], v[140:143], v[132:135]
  s_waitcnt lgkmcnt(7)
  ds_read_b64_tr_b16 v[158:159], v29 offset:48128
  v_fma_f32 v101, v101, v17, v17
  v_mfma_f32_16x16x32_bf16 v[112:115], a[84:87], v[144:147], v[112:115]
  ds_write_b32 v37, v72 offset:0
  v_mfma_f32_16x16x32_bf16 v[116:119], a[88:91], v[144:147], v[116:119]
  v_rcp_f32 v101, v101
  v_mfma_f32_16x16x32_bf16 v[120:123], a[92:95], v[144:147], v[120:123]
  s_waitcnt lgkmcnt(7)
  global_load_dwordx4 a[4:7], v2, s[20:21] offset:1024 sc1
  ds_read_b64_tr_b16 v[136:137], v28 offset:49152
  v_mfma_f32_16x16x32_bf16 v[124:127], a[84:87], v[148:151], v[124:127]
  ds_write_b64 v36, v[84:85] offset:1024
  v_mfma_f32_16x16x32_bf16 v[128:131], a[88:91], v[148:151], v[128:131]
  ds_read_b64_tr_b16 v[138:139], v28 offset:50176
  ds_read_b64_tr_b16 v[140:141], v29 offset:49152
  v_mfma_f32_16x16x32_bf16 v[132:135], a[92:95], v[148:151], v[132:135]
  s_waitcnt lgkmcnt(7)
  ds_write_b64 v36, v[86:87] offset:1032
  ds_read_b64_tr_b16 v[142:143], v29 offset:50176
  v_mfma_f32_16x16x32_bf16 v[112:115], a[96:99], v[152:155], v[112:115]
  ds_write_b32 v37, v76 offset:256
  v_mfma_f32_16x16x32_bf16 v[116:119], a[100:103], v[152:155], v[116:119]
  global_load_dwordx4 a[8:11], v2, s[20:21] offset:2048 sc1
  ds_read_b64_tr_b16 v[144:145], v30 offset:40960
  v_mfma_f32_16x16x32_bf16 v[120:123], a[104:107], v[152:155], v[120:123]
  s_waitcnt lgkmcnt(9)
  ds_read_b64_tr_b16 v[146:147], v30 offset:41984
  ds_read_b64_tr_b16 v[148:149], v31 offset:40960
  v_mfma_f32_16x16x32_bf16 v[124:127], a[96:99], v[156:159], v[124:127]
  ds_read_b64_tr_b16 v[150:151], v31 offset:41984
  v_fma_f32 v102, v102, v17, v17
  v_mfma_f32_16x16x32_bf16 v[128:131], a[100:103], v[156:159], v[128:131]
  v_rcp_f32 v102, v102
  v_mfma_f32_16x16x32_bf16 v[132:135], a[104:107], v[156:159], v[132:135]
  s_waitcnt lgkmcnt(8)
  v_fma_f32 v103, v103, v17, v17
  v_mul_f32 v104, v104, v100
  v_mfma_f32_16x16x32_bf16 v[112:115], a[108:111], v[136:139], v[112:115]
  global_load_dwordx4 a[12:15], v2, s[20:21] offset:3072 sc1
  ds_read_b64_tr_b16 v[152:153], v30 offset:43008
  v_mfma_f32_16x16x32_bf16 v[116:119], a[112:115], v[136:139], v[116:119]
  v_rcp_f32 v103, v103
  v_mfma_f32_16x16x32_bf16 v[120:123], a[116:119], v[136:139], v[120:123]
  s_waitcnt lgkmcnt(6)
  ds_read_b64_tr_b16 v[154:155], v30 offset:44032
  ds_read_b64_tr_b16 v[156:157], v31 offset:43008
  v_mfma_f32_16x16x32_bf16 v[124:127], a[108:111], v[140:143], v[124:127]
  ds_read_b64_tr_b16 v[158:159], v31 offset:44032
  v_mul_f32 v105, v105, v101
  v_mfma_f32_16x16x32_bf16 v[128:131], a[112:115], v[140:143], v[128:131]
  v_mul_f32 v106, v106, v102
  v_mul_f32 v107, v107, v103
  v_mfma_f32_16x16x32_bf16 v[132:135], a[116:119], v[140:143], v[132:135]
  s_waitcnt lgkmcnt(6)
  v_add_u32 v2, 8192, v2
  global_load_dwordx4 a[16:19], v2, s[20:21] offset:-4096 sc1
  v_mfma_f32_16x16x32_bf16 v[112:115], a[120:123], v[144:147], v[112:115]
  ds_read_b64_tr_b16 v[136:137], v30 offset:45056
  ds_read_b64_tr_b16 v[138:139], v30 offset:46080
  v_mfma_f32_16x16x32_bf16 v[116:119], a[124:127], v[144:147], v[116:119]
  ds_read_b64_tr_b16 v[140:141], v31 offset:45056
  ds_read_b64_tr_b16 v[142:143], v31 offset:46080
  v_mfma_f32_16x16x32_bf16 v[120:123], a[128:131], v[144:147], v[120:123]
  s_waitcnt lgkmcnt(8)
  v_cvt_pk_bf16_f32 v20, v104, v105
  v_cvt_pk_bf16_f32 v21, v106, v107
  v_mfma_f32_16x16x32_bf16 v[124:127], a[120:123], v[148:151], v[124:127]
  v_permlane16_swap_b32 v96, v108
  v_permlane16_swap_b32 v97, v109
  v_mfma_f32_16x16x32_bf16 v[128:131], a[124:127], v[148:151], v[128:131]
  s_barrier
  global_load_dwordx4 a[20:23], v2, s[20:21] offset:-3072 sc1
  v_permlane16_swap_b32 v98, v110
  v_mfma_f32_16x16x32_bf16 v[132:135], a[128:131], v[148:151], v[132:135]
  s_waitcnt lgkmcnt(6)
  v_permlane16_swap_b32 v99, v111
  v_permlane16_swap_b32 v18, v20
  v_mfma_f32_16x16x32_bf16 v[112:115], a[132:135], v[152:155], v[112:115]
  ds_read_b64_tr_b16 v[144:145], v30 offset:47104
  ds_read_b64_tr_b16 v[146:147], v30 offset:48128
  v_mfma_f32_16x16x32_bf16 v[116:119], a[136:139], v[152:155], v[116:119]
  ds_read_b64_tr_b16 v[148:149], v31 offset:47104
  ds_read_b64_tr_b16 v[150:151], v31 offset:48128
  v_mfma_f32_16x16x32_bf16 v[120:123], a[140:143], v[152:155], v[120:123]
  s_waitcnt lgkmcnt(8)
  v_permlane16_swap_b32 v19, v21
  v_fmac_f32 v96, v9, v64
  v_mfma_f32_16x16x32_bf16 v[124:127], a[132:135], v[156:159], v[124:127]
  global_load_dwordx4 a[24:27], v2, s[20:21] offset:-2048 sc1
  v_fmac_f32 v97, v9, v65
  v_mfma_f32_16x16x32_bf16 v[128:131], a[136:139], v[156:159], v[128:131]
  buffer_store_dwordx4 v[18:21], v34, s[20:23], s18 offen sc1
  v_mfma_f32_16x16x32_bf16 v[132:135], a[140:143], v[156:159], v[132:135]
  s_waitcnt lgkmcnt(6)
  v_fmac_f32 v98, v9, v66
  v_fmac_f32 v99, v9, v67
  v_mfma_f32_16x16x32_bf16 v[112:115], a[144:147], v[136:139], v[112:115]
  ds_read_b64_tr_b16 v[152:153], v30 offset:49152
  ds_read_b64_tr_b16 v[154:155], v30 offset:50176
  v_mfma_f32_16x16x32_bf16 v[116:119], a[148:151], v[136:139], v[116:119]
  ds_read_b64_tr_b16 v[156:157], v31 offset:49152
  ds_read_b64_tr_b16 v[158:159], v31 offset:50176
  v_mfma_f32_16x16x32_bf16 v[120:123], a[152:155], v[136:139], v[120:123]
  s_waitcnt lgkmcnt(8)
  global_load_dwordx4 a[28:31], v2, s[20:21] offset:-1024 sc1
  v_fmac_f32 v108, v9, v68
  v_mfma_f32_16x16x32_bf16 v[124:127], a[144:147], v[140:143], v[124:127]
  v_fmac_f32 v109, v9, v69
  v_fmac_f32 v110, v9, v70
  v_mfma_f32_16x16x32_bf16 v[128:131], a[148:151], v[140:143], v[128:131]
  v_fmac_f32 v111, v9, v71
  v_mul_f32 v108, v96, v108
  v_mfma_f32_16x16x32_bf16 v[132:135], a[152:155], v[140:143], v[132:135]
  s_waitcnt lgkmcnt(6)
  v_mul_f32 v109, v97, v109
  v_mul_f32 v110, v98, v110
  v_mfma_f32_16x16x32_bf16 v[112:115], a[156:159], v[144:147], v[112:115]
  ds_read_b64_tr_b16 v[136:137], v32 offset:40960
  ds_read_b64_tr_b16 v[138:139], v32 offset:41984
  v_mfma_f32_16x16x32_bf16 v[116:119], a[160:163], v[144:147], v[116:119]
  global_load_dwordx4 a[96:99], v53, s[20:21] offset:3072 sc1
  ds_read_b64_tr_b16 v[140:141], v33 offset:40960
  v_mfma_f32_16x16x32_bf16 v[120:123], a[164:167], v[144:147], v[120:123]
  s_waitcnt lgkmcnt(7)
  ds_read_b64_tr_b16 v[142:143], v33 offset:41984
  v_mul_f32 v111, v99, v111
  v_mfma_f32_16x16x32_bf16 v[124:127], a[156:159], v[148:151], v[124:127]
  v_mul_f32 v96, v96, v10
  v_mul_f32 v97, v97, v10
  v_mfma_f32_16x16x32_bf16 v[128:131], a[160:163], v[148:151], v[128:131]
  v_exp_f32 v96, v96
  v_mfma_f32_16x16x32_bf16 v[132:135], a[164:167], v[148:151], v[132:135]
  s_waitcnt lgkmcnt(6)
  v_exp_f32 v97, v97
  v_mfma_f32_16x16x32_bf16 v[112:115], a[168:171], v[152:155], v[112:115]
  v_add_u32 v53, 8192, v53
  global_load_dwordx4 a[100:103], v53, s[20:21] offset:-4096 sc1
  v_mfma_f32_16x16x32_bf16 v[116:119], a[172:175], v[152:155], v[116:119]
  buffer_load_dword v8, v41, s[20:23], 0 offen sc1
  v_mfma_f32_16x16x32_bf16 v[120:123], a[176:179], v[152:155], v[120:123]
  s_waitcnt lgkmcnt(4)
  ds_read_b64_tr_b16 v[144:145], v32 offset:43008
  ds_read_b64_tr_b16 v[146:147], v32 offset:44032
  v_mfma_f32_16x16x32_bf16 v[124:127], a[168:171], v[156:159], v[124:127]
  ds_read_b64_tr_b16 v[148:149], v33 offset:43008
  ds_read_b64_tr_b16 v[150:151], v33 offset:44032
  v_mfma_f32_16x16x32_bf16 v[128:131], a[172:175], v[156:159], v[128:131]
  v_mul_f32 v98, v98, v10
  v_mul_f32 v99, v99, v10
  v_mfma_f32_16x16x32_bf16 v[132:135], a[176:179], v[156:159], v[132:135]
  s_waitcnt lgkmcnt(6)
  global_load_dwordx4 a[104:107], v53, s[20:21] offset:-3072 sc1
  ds_read2st64_b32 v[18:19], v39 offset0:0 offset1:2
  v_mfma_f32_16x16x32_bf16 v[112:115], a[180:183], v[136:139], v[112:115]
  v_exp_f32 v98, v98
  v_mfma_f32_16x16x32_bf16 v[116:119], a[184:187], v[136:139], v[116:119]
  v_exp_f32 v99, v99
  v_mfma_f32_16x16x32_bf16 v[120:123], a[188:191], v[136:139], v[120:123]
  s_waitcnt lgkmcnt(5)
  ds_read_b64_tr_b16 v[152:153], v32 offset:45056
  ds_read_b64_tr_b16 v[154:155], v32 offset:46080
  v_mfma_f32_16x16x32_bf16 v[124:127], a[180:183], v[140:143], v[124:127]
  ds_read_b64_tr_b16 v[156:157], v33 offset:45056
  ds_read_b64_tr_b16 v[158:159], v33 offset:46080
  v_mfma_f32_16x16x32_bf16 v[128:131], a[184:187], v[140:143], v[128:131]
  global_load_dwordx4 a[108:111], v53, s[20:21] offset:-2048 sc1
  ds_read2st64_b32 v[20:21], v39 offset0:4 offset1:6
  v_mfma_f32_16x16x32_bf16 v[132:135], a[188:191], v[140:143], v[132:135]
  s_waitcnt lgkmcnt(8)
  ds_read2st64_b32 v[22:23], v38 offset0:0 offset1:8
  ds_read2st64_b32 v[24:25], v38 offset0:16 offset1:24
  v_mfma_f32_16x16x32_bf16 v[112:115], a[192:195], v[144:147], v[112:115]
  ds_read_b64_tr_b16 v[136:137], v32 offset:47104
  ds_read_b64_tr_b16 v[138:139], v32 offset:48128
  v_mfma_f32_16x16x32_bf16 v[116:119], a[196:199], v[144:147], v[116:119]
  ds_read_b64_tr_b16 v[140:141], v33 offset:47104
  ds_read_b64_tr_b16 v[142:143], v33 offset:48128
  v_mfma_f32_16x16x32_bf16 v[120:123], a[200:203], v[144:147], v[120:123]
  s_waitcnt lgkmcnt(12)
  v_fma_f32 v96, v96, v11, v11
  v_fma_f32 v97, v97, v11, v11
  v_mfma_f32_16x16x32_bf16 v[124:127], a[192:195], v[148:151], v[124:127]
  global_load_dwordx4 a[112:115], v53, s[20:21] offset:-1024 sc1
  v_fma_f32 v98, v98, v11, v11
  v_mfma_f32_16x16x32_bf16 v[128:131], a[196:199], v[148:151], v[128:131]
  v_rcp_f32 v96, v96
  v_mfma_f32_16x16x32_bf16 v[132:135], a[200:203], v[148:151], v[132:135]
  s_waitcnt lgkmcnt(9)
  v_rcp_f32 v97, v97
  v_mfma_f32_16x16x32_bf16 v[112:115], a[204:207], v[152:155], v[112:115]
  v_rcp_f32 v98, v98
  v_mfma_f32_16x16x32_bf16 v[116:119], a[208:211], v[152:155], v[116:119]
  ds_read_b64_tr_b16 v[144:145], v32 offset:49152
  ds_read_b64_tr_b16 v[146:147], v32 offset:50176
  v_mfma_f32_16x16x32_bf16 v[120:123], a[212:215], v[152:155], v[120:123]
  s_waitcnt lgkmcnt(9)
  global_load_dwordx4 a[116:119], v53, s[20:21] offset:0 sc1
  ds_read_b64_tr_b16 v[148:149], v33 offset:49152
  v_mfma_f32_16x16x32_bf16 v[124:127], a[204:207], v[156:159], v[124:127]
  ds_read_b64_tr_b16 v[150:151], v33 offset:50176
  v_fma_f32 v99, v99, v11, v11
  v_mfma_f32_16x16x32_bf16 v[128:131], a[208:211], v[156:159], v[128:131]
  v_rcp_f32 v99, v99
  v_mfma_f32_16x16x32_bf16 v[132:135], a[212:215], v[156:159], v[132:135]
  s_waitcnt lgkmcnt(6)
  v_mul_f32 v108, v108, v96
  v_mul_f32 v109, v109, v97
  v_mfma_f32_16x16x32_bf16 v[112:115], a[216:219], v[136:139], v[112:115]
  v_mul_f32 v110, v110, v98
  v_mul_f32 v111, v111, v99
  v_mfma_f32_16x16x32_bf16 v[116:119], a[220:223], v[136:139], v[116:119]
  global_load_dwordx4 a[120:123], v53, s[20:21] offset:1024 sc1
  v_cvt_pk_bf16_f32 v54, v108, v109
  v_mfma_f32_16x16x32_bf16 v[120:123], a[224:227], v[136:139], v[120:123]
  s_waitcnt lgkmcnt(4)
  v_cvt_pk_bf16_f32 v55, v110, v111
  v_mfma_f32_16x16x32_bf16 v[124:127], a[216:219], v[140:143], v[124:127]
  buffer_store_dwordx2 v[54:55], v35, s[20:23], s18 offen sc1
  v_mfma_f32_16x16x32_bf16 v[128:131], a[220:223], v[140:143], v[128:131]
  s_add_u32 s18, s18, 98304
  v_add_f32 v18, v18, v19
  v_mfma_f32_16x16x32_bf16 v[132:135], a[224:227], v[140:143], v[132:135]
  s_waitcnt lgkmcnt(2)
  v_add_f32 v20, v20, v21
  v_add_f32 v22, v22, v23
  v_mfma_f32_16x16x32_bf16 v[112:115], a[228:231], v[144:147], v[112:115]
  global_load_dwordx4 a[124:127], v53, s[20:21] offset:2048 sc1
  v_add_f32 v24, v24, v25
  v_mfma_f32_16x16x32_bf16 v[116:119], a[232:235], v[144:147], v[116:119]
  v_add_f32 v18, v18, v20
  v_add_f32 v22, v22, v24
  v_mfma_f32_16x16x32_bf16 v[120:123], a[236:239], v[144:147], v[120:123]
  s_waitcnt lgkmcnt(0)
  v_mul_f32 v9, -0.0015625, v18
  v_mul_f32 v11, 0.0015625, v22
  v_mfma_f32_16x16x32_bf16 v[124:127], a[228:231], v[148:151], v[124:127]
  v_fma_f32 v11, -v9, v9, v11
  v_max_f32 v11, 0, v11
  v_mfma_f32_16x16x32_bf16 v[128:131], a[232:235], v[148:151], v[128:131]
  v_add_f32 v11, 1e-05, v11
  v_mov_b32 v12, v9
  v_mfma_f32_16x16x32_bf16 v[132:135], a[236:239], v[148:151], v[132:135]
  v_rsq_f32 v10, v11
  s_nop 0
  v_mul_f32 v10, -1.4426950408889634, v10
  v_mov_b32 v15, v9
  v_mov_b32 v14, v11
  v_mov_b32 v17, v11
  v_mov_b32 v13, v10
  v_mov_b32 v16, v10
  v_permlane16_swap_b32 v12, v15
  v_permlane16_swap_b32 v14, v17
  v_permlane16_swap_b32 v13, v16
  s_waitcnt vmcnt(7)
  v_cmp_gt_u32 vcc, 2, v8
  s_cbranch_vccnz slow_23
back_24:
  v_mov_b32 v3, 3
  v_fmac_f32 v112, v12, v56
  v_add_u32 v2, 94208, v2
  global_load_dwordx4 a[48:51], v2, s[20:21] offset:-4096 sc1
  v_fmac_f32 v113, v12, v57
  v_fmac_f32 v114, v12, v58
  v_fmac_f32 v115, v12, v59
  v_fmac_f32 v116, v12, v60
  v_fmac_f32 v117, v12, v61
  v_fmac_f32 v118, v12, v62
  v_fmac_f32 v119, v12, v63
  v_mul_f32 v116, v112, v116
  v_mul_f32 v117, v113, v117
  v_mul_f32 v118, v114, v118
  v_mul_f32 v119, v115, v119
  v_mul_f32 v112, v112, v13
  v_mul_f32 v113, v113, v13
  v_mul_f32 v114, v114, v13
  global_load_dwordx4 a[52:55], v2, s[20:21] offset:-3072 sc1
  v_mul_f32 v115, v115, v13
  v_exp_f32 v112, v112
  v_exp_f32 v113, v113
  v_exp_f32 v114, v114
  v_exp_f32 v115, v115
  v_fma_f32 v112, v112, v14, v14
  v_fma_f32 v113, v113, v14, v14
  v_fma_f32 v114, v114, v14, v14
  v_fma_f32 v115, v115, v14, v14
  v_rcp_f32 v112, v112
  v_rcp_f32 v113, v113
  v_rcp_f32 v114, v114
  v_rcp_f32 v115, v115
  v_mul_f32 v116, v116, v112
  global_load_dwordx4 a[56:59], v2, s[20:21] offset:-2048 sc1
  v_mul_f32 v117, v117, v113
  v_mul_f32 v118, v118, v114
  v_mul_f32 v119, v119, v115
  v_cvt_pk_bf16_f32 v18, v116, v117
  v_cvt_pk_bf16_f32 v19, v118, v119
  v_fmac_f32 v124, v15, v56
  v_fmac_f32 v125, v15, v57
  v_fmac_f32 v126, v15, v58
  v_fmac_f32 v127, v15, v59
  v_fmac_f32 v128, v15, v60
  v_fmac_f32 v129, v15, v61
  v_fmac_f32 v130, v15, v62
  v_fmac_f32 v131, v15, v63
  v_mul_f32 v128, v124, v128
  global_load_dwordx4 a[60:63], v2, s[20:21] offset:-1024 sc1
  v_mul_f32 v129, v125, v129
  v_mul_f32 v130, v126, v130
  v_mul_f32 v131, v127, v131
  v_mul_f32 v124, v124, v16
  v_mul_f32 v125, v125, v16
  v_mul_f32 v126, v126, v16
  v_mul_f32 v127, v127, v16
  v_exp_f32 v124, v124
  s_waitcnt vmcnt(5)
  buffer_store_dword v3, v40, s[20:23], 0 offen sc1
  v_exp_f32 v125, v125
  v_exp_f32 v126, v126
  v_exp_f32 v127, v127
  v_fma_f32 v124, v124, v17, v17
  v_fma_f32 v125, v125, v17, v17
  v_fma_f32 v126, v126, v17, v17
  global_load_dwordx4 a[64:67], v2, s[20:21] offset:0 sc1
  v_fma_f32 v127, v127, v17, v17
  v_rcp_f32 v124, v124
  v_rcp_f32 v125, v125
  v_rcp_f32 v126, v126
  v_rcp_f32 v127, v127
  v_mul_f32 v128, v128, v124
  v_mul_f32 v129, v129, v125
  v_mul_f32 v130, v130, v126
  v_mul_f32 v131, v131, v127
  v_cvt_pk_bf16_f32 v20, v128, v129
  v_cvt_pk_bf16_f32 v21, v130, v131
  v_permlane16_swap_b32 v120, v132
  v_permlane16_swap_b32 v121, v133
  v_permlane16_swap_b32 v122, v134
  global_load_dwordx4 a[68:71], v2, s[20:21] offset:1024 sc1
  v_permlane16_swap_b32 v123, v135
  v_permlane16_swap_b32 v18, v20
  v_permlane16_swap_b32 v19, v21
  buffer_store_dwordx4 v[18:21], v34, s[20:23], s18 offen sc1
  v_fmac_f32 v120, v9, v64
  v_fmac_f32 v121, v9, v65
  v_fmac_f32 v122, v9, v66
  v_fmac_f32 v123, v9, v67
  v_fmac_f32 v132, v9, v68
  v_fmac_f32 v133, v9, v69
  v_fmac_f32 v134, v9, v70
  v_fmac_f32 v135, v9, v71
  v_mul_f32 v132, v120, v132
  v_mul_f32 v133, v121, v133
  global_load_dwordx4 a[72:75], v2, s[20:21] offset:2048 sc1
  v_mul_f32 v134, v122, v134
  v_mul_f32 v135, v123, v135
  v_mul_f32 v120, v120, v10
  v_mul_f32 v121, v121, v10
  v_mul_f32 v122, v122, v10
  v_mul_f32 v123, v123, v10
  v_exp_f32 v120, v120
  v_exp_f32 v121, v121
  v_exp_f32 v122, v122
  v_exp_f32 v123, v123
  v_fma_f32 v120, v120, v11, v11
  v_fma_f32 v121, v121, v11, v11
  v_fma_f32 v122, v122, v11, v11
  v_fma_f32 v123, v123, v11, v11
  global_load_dwordx4 a[76:79], v2, s[20:21] offset:3072 sc1
  v_rcp_f32 v120, v120
  v_rcp_f32 v121, v121
  v_rcp_f32 v122, v122
  v_rcp_f32 v123, v123
  v_mul_f32 v132, v132, v120
  v_mul_f32 v133, v133, v121
  v_mul_f32 v134, v134, v122
  v_mul_f32 v135, v135, v123
  v_cvt_pk_bf16_f32 v54, v132, v133
  v_cvt_pk_bf16_f32 v55, v134, v135
  buffer_store_dwordx2 v[54:55], v35, s[20:23], s18 offen sc1
  v_mfma_f32_16x16x32_bf16 v[88:91], v[188:191], a[0:3], 0
  v_add_u32 v2, 4294877184, v2
  global_load_dwordx4 a[32:35], v2, s[20:21] offset:-4096 sc1
  v_mfma_f32_16x16x32_bf16 v[92:95], v[192:195], a[0:3], 0
  v_mfma_f32_16x16x32_bf16 v[96:99], v[196:199], a[0:3], 0
  ds_read_b128 a[164:167], v52 offset:0
  v_mfma_f32_16x16x32_bf16 v[100:103], v[200:203], a[0:3], 0
  ds_read_b128 a[168:171], v52 offset:1024
  v_mfma_f32_16x16x32_bf16 v[104:107], v[204:207], a[0:3], 0
  global_load_dwordx4 a[36:39], v2, s[20:21] offset:-3072 sc1
  ds_read_b128 a[172:175], v52 offset:2048
  v_mfma_f32_16x16x32_bf16 v[88:91], v[208:211], a[4:7], v[88:91]
  ds_read_b128 a[176:179], v52 offset:3072
  v_mfma_f32_16x16x32_bf16 v[92:95], v[212:215], a[4:7], v[92:95]
  ds_read_b128 a[180:183], v52 offset:4096
  v_mfma_f32_16x16x32_bf16 v[96:99], v[216:219], a[4:7], v[96:99]
  ds_read_b128 a[184:187], v52 offset:5120
  v_mfma_f32_16x16x32_bf16 v[100:103], v[220:223], a[4:7], v[100:103]
  global_load_dwordx4 a[40:43], v2, s[20:21] offset:-2048 sc1
  ds_read_b128 a[188:191], v52 offset:6144
  v_mfma_f32_16x16x32_bf16 v[104:107], v[224:227], a[4:7], v[104:107]
  ds_read_b128 a[192:195], v52 offset:7168
  v_mfma_f32_16x16x32_bf16 v[88:91], v[228:231], a[8:11], v[88:91]
  ds_read_b128 a[196:199], v52 offset:8192
  v_mfma_f32_16x16x32_bf16 v[92:95], v[232:235], a[8:11], v[92:95]
  ds_read_b128 a[200:203], v52 offset:9216
  v_mfma_f32_16x16x32_bf16 v[96:99], v[236:239], a[8:11], v[96:99]
  global_load_dwordx4 a[128:131], v53, s[20:21] offset:3072 sc1
  ds_read_b128 a[204:207], v52 offset:10240
  v_mfma_f32_16x16x32_bf16 v[100:103], v[240:243], a[8:11], v[100:103]
  ds_read_b128 a[208:211], v52 offset:11264
  v_mfma_f32_16x16x32_bf16 v[104:107], v[244:247], a[8:11], v[104:107]
  ds_read_b128 a[212:215], v52 offset:12288
  v_mfma_f32_16x16x32_bf16 v[88:91], v[248:251], a[12:15], v[88:91]
  ds_read_b128 a[216:219], v52 offset:13312
  v_mfma_f32_16x16x32_bf16 v[92:95], v[252:255], a[12:15], v[92:95]
  v_add_u32 v53, 8192, v53
  global_load_dwordx4 a[132:135], v53, s[20:21] offset:-4096 sc1
  v_mfma_f32_16x16x32_bf16 v[96:99], v[160:163], a[12:15], v[96:99]
  ds_read_b128 a[220:223], v52 offset:14336
  v_mfma_f32_16x16x32_bf16 v[100:103], v[164:167], a[12:15], v[100:103]
  v_mfma_f32_16x16x32_bf16 v[104:107], v[168:171], a[12:15], v[104:107]
  v_mfma_f32_16x16x32_bf16 v[88:91], v[172:175], a[16:19], v[88:91]
  global_load_dwordx4 a[136:139], v53, s[20:21] offset:-3072 sc1
  v_mfma_f32_16x16x32_bf16 v[92:95], v[176:179], a[16:19], v[92:95]
  v_mfma_f32_16x16x32_bf16 v[96:99], v[180:183], a[16:19], v[96:99]
  v_mfma_f32_16x16x32_bf16 v[100:103], v[184:187], a[16:19], v[100:103]
  v_mfma_f32_16x16x32_bf16 v[104:107], a[240:243], a[16:19], v[104:107]
  global_load_dwordx4 a[140:143], v53, s[20:21] offset:-2048 sc1
  v_mfma_f32_16x16x32_bf16 v[88:91], a[244:247], a[20:23], v[88:91]
  v_mfma_f32_16x16x32_bf16 v[92:95], a[248:251], a[20:23], v[92:95]
  v_mfma_f32_16x16x32_bf16 v[96:99], a[252:255], a[20:23], v[96:99]
  s_waitcnt lgkmcnt(14)
  v_mfma_f32_16x16x32_bf16 v[100:103], a[164:167], a[20:23], v[100:103]
  s_waitcnt lgkmcnt(13)
  global_load_dwordx4 a[44:47], v2, s[20:21] offset:-1024 sc1
  v_mfma_f32_16x16x32_bf16 v[104:107], a[168:171], a[20:23], v[104:107]
  s_waitcnt lgkmcnt(12)
  v_mfma_f32_16x16x32_bf16 v[88:91], a[172:175], a[24:27], v[88:91]
  s_waitcnt lgkmcnt(11)
  buffer_load_dword v8, v41, s[20:23], 0 offen sc1
  v_mfma_f32_16x16x32_bf16 v[92:95], a[176:179], a[24:27], v[92:95]
  s_waitcnt lgkmcnt(10)
  v_mfma_f32_16x16x32_bf16 v[96:99], a[180:183], a[24:27], v[96:99]
  s_waitcnt lgkmcnt(9)
  global_load_dwordx4 a[144:147], v53, s[20:21] offset:-1024 sc1
  v_mfma_f32_16x16x32_bf16 v[100:103], a[184:187], a[24:27], v[100:103]
  s_waitcnt lgkmcnt(8)
  v_mfma_f32_16x16x32_bf16 v[104:107], a[188:191], a[24:27], v[104:107]
  s_waitcnt lgkmcnt(7)
  v_mfma_f32_16x16x32_bf16 v[88:91], a[192:195], a[28:31], v[88:91]
  s_waitcnt lgkmcnt(6)
  v_mfma_f32_16x16x32_bf16 v[92:95], a[196:199], a[28:31], v[92:95]
  s_waitcnt lgkmcnt(5)
  global_load_dwordx4 a[148:151], v53, s[20:21] offset:0 sc1
  v_mfma_f32_16x16x32_bf16 v[96:99], a[200:203], a[28:31], v[96:99]
  s_waitcnt lgkmcnt(4)
  v_mfma_f32_16x16x32_bf16 v[100:103], a[204:207], a[28:31], v[100:103]
  s_waitcnt lgkmcnt(3)
  v_mfma_f32_16x16x32_bf16 v[104:107], a[208:211], a[28:31], v[104:107]
  s_waitcnt vmcnt(21)
  v_mfma_f32_16x16x32_bf16 v[136:139], v[188:191], a[48:51], 0
  global_load_dwordx4 a[152:155], v53, s[20:21] offset:1024 sc1
  v_mfma_f32_16x16x32_bf16 v[140:143], v[192:195], a[48:51], 0
  v_mfma_f32_16x16x32_bf16 v[144:147], v[196:199], a[48:51], 0
  v_mfma_f32_16x16x32_bf16 v[148:151], v[200:203], a[48:51], 0
  v_mfma_f32_16x16x32_bf16 v[152:155], v[204:207], a[48:51], 0
  s_waitcnt vmcnt(21)
  global_load_dwordx4 a[156:159], v53, s[20:21] offset:2048 sc1
  v_mfma_f32_16x16x32_bf16 v[136:139], v[208:211], a[52:55], v[136:139]
  v_mfma_f32_16x16x32_bf16 v[140:143], v[212:215], a[52:55], v[140:143]
  v_mfma_f32_16x16x32_bf16 v[144:147], v[216:219], a[52:55], v[144:147]
  v_mfma_f32_16x16x32_bf16 v[148:151], v[220:223], a[52:55], v[148:151]
  global_load_dwordx4 a[160:163], v53, s[20:21] offset:3072 sc1
  v_mfma_f32_16x16x32_bf16 v[152:155], v[224:227], a[52:55], v[152:155]
  s_waitcnt vmcnt(22)
  v_mfma_f32_16x16x32_bf16 v[136:139], v[228:231], a[56:59], v[136:139]
  v_mfma_f32_16x16x32_bf16 v[140:143], v[232:235], a[56:59], v[140:143]
  v_mfma_f32_16x16x32_bf16 v[144:147], v[236:239], a[56:59], v[144:147]
  v_add_u32 v2, 98304, v2
  global_load_dwordx4 a[80:83], v2, s[20:21] offset:-4096 sc1
  v_mfma_f32_16x16x32_bf16 v[148:151], v[240:243], a[56:59], v[148:151]
  v_mfma_f32_16x16x32_bf16 v[152:155], v[244:247], a[56:59], v[152:155]
  s_waitcnt vmcnt(22)
  v_mfma_f32_16x16x32_bf16 v[136:139], v[248:251], a[60:63], v[136:139]
  v_mov_b32 v3, 4
  s_waitcnt vmcnt(15)
  buffer_store_dword v3, v40, s[20:23], 0 offen sc1
  v_mfma_f32_16x16x32_bf16 v[140:143], v[252:255], a[60:63], v[140:143]
  global_load_dwordx4 a[84:87], v2, s[20:21] offset:-3072 sc1
  v_mfma_f32_16x16x32_bf16 v[144:147], v[160:163], a[60:63], v[144:147]
  v_mfma_f32_16x16x32_bf16 v[148:151], v[164:167], a[60:63], v[148:151]
  v_mfma_f32_16x16x32_bf16 v[152:155], v[168:171], a[60:63], v[152:155]
  s_barrier
  v_mfma_f32_16x16x32_bf16 v[136:139], v[172:175], a[64:67], v[136:139]
  global_load_dwordx4 a[88:91], v2, s[20:21] offset:-2048 sc1
  v_mfma_f32_16x16x32_bf16 v[140:143], v[176:179], a[64:67], v[140:143]
  v_mfma_f32_16x16x32_bf16 v[144:147], v[180:183], a[64:67], v[144:147]
  v_mfma_f32_16x16x32_bf16 v[148:151], v[184:187], a[64:67], v[148:151]
  v_mfma_f32_16x16x32_bf16 v[152:155], a[240:243], a[64:67], v[152:155]
  global_load_dwordx4 a[92:95], v2, s[20:21] offset:-1024 sc1
  v_mfma_f32_16x16x32_bf16 v[136:139], a[244:247], a[68:71], v[136:139]
  v_mfma_f32_16x16x32_bf16 v[140:143], a[248:251], a[68:71], v[140:143]
  v_mfma_f32_16x16x32_bf16 v[144:147], a[252:255], a[68:71], v[144:147]
  v_mfma_f32_16x16x32_bf16 v[148:151], a[164:167], a[68:71], v[148:151]
  v_mfma_f32_16x16x32_bf16 v[152:155], a[168:171], a[68:71], v[152:155]
  v_mfma_f32_16x16x32_bf16 v[136:139], a[172:175], a[72:75], v[136:139]
  v_mfma_f32_16x16x32_bf16 v[140:143], a[176:179], a[72:75], v[140:143]
  v_mfma_f32_16x16x32_bf16 v[144:147], a[180:183], a[72:75], v[144:147]
  v_mfma_f32_16x16x32_bf16 v[148:151], a[184:187], a[72:75], v[148:151]
  v_mfma_f32_16x16x32_bf16 v[152:155], a[188:191], a[72:75], v[152:155]
  v_mfma_f32_16x16x32_bf16 v[136:139], a[192:195], a[76:79], v[136:139]
  s_waitcnt vmcnt(10)
  v_cmp_gt_u32 vcc, 3, v8
  s_cbranch_vccnz slow_25
back_26:
  v_mfma_f32_16x16x32_bf16 v[140:143], a[196:199], a[76:79], v[140:143]
  v_add_u32 v2, 3039232, v2
  global_load_dwordx4 a[0:3], v2, s[20:21] offset:-4096 sc1
  v_mfma_f32_16x16x32_bf16 v[144:147], a[200:203], a[76:79], v[144:147]
  v_mfma_f32_16x16x32_bf16 v[148:151], a[204:207], a[76:79], v[148:151]
  v_mfma_f32_16x16x32_bf16 v[152:155], a[208:211], a[76:79], v[152:155]
  s_waitcnt lgkmcnt(2)
  v_mfma_f32_16x16x32_bf16 v[88:91], a[212:215], a[32:35], v[88:91]
  s_waitcnt lgkmcnt(1)
  global_load_dwordx4 a[4:7], v2, s[20:21] offset:-3072 sc1
  v_mfma_f32_16x16x32_bf16 v[92:95], a[216:219], a[32:35], v[92:95]
  s_waitcnt lgkmcnt(0)
  v_mfma_f32_16x16x32_bf16 v[96:99], a[220:223], a[32:35], v[96:99]
  v_mfma_f32_16x16x32_bf16 v[100:103], a[96:99], a[32:35], v[100:103]
  v_mfma_f32_16x16x32_bf16 v[104:107], a[100:103], a[32:35], v[104:107]
  global_load_dwordx4 a[8:11], v2, s[20:21] offset:-2048 sc1
  v_mfma_f32_16x16x32_bf16 v[88:91], a[104:107], a[36:39], v[88:91]
  v_mfma_f32_16x16x32_bf16 v[92:95], a[108:111], a[36:39], v[92:95]
  v_mfma_f32_16x16x32_bf16 v[96:99], a[112:115], a[36:39], v[96:99]
  v_mfma_f32_16x16x32_bf16 v[100:103], a[116:119], a[36:39], v[100:103]
  global_load_dwordx4 a[12:15], v2, s[20:21] offset:-1024 sc1
  v_mfma_f32_16x16x32_bf16 v[104:107], a[120:123], a[36:39], v[104:107]
  v_mfma_f32_16x16x32_bf16 v[88:91], a[124:127], a[40:43], v[88:91]
  v_mfma_f32_16x16x32_bf16 v[92:95], a[128:131], a[40:43], v[92:95]
  v_mfma_f32_16x16x32_bf16 v[96:99], a[132:135], a[40:43], v[96:99]
  global_load_dwordx4 a[16:19], v2, s[20:21] offset:0 sc1
  v_mfma_f32_16x16x32_bf16 v[100:103], a[136:139], a[40:43], v[100:103]
  v_mfma_f32_16x16x32_bf16 v[104:107], a[140:143], a[40:43], v[104:107]
  s_waitcnt vmcnt(14)
  v_mfma_f32_16x16x32_bf16 v[88:91], a[144:147], a[44:47], v[88:91]
  s_waitcnt vmcnt(13)
  v_mfma_f32_16x16x32_bf16 v[92:95], a[148:151], a[44:47], v[92:95]
  s_waitcnt vmcnt(12)
  global_load_dwordx4 a[20:23], v2, s[20:21] offset:1024 sc1
  v_mfma_f32_16x16x32_bf16 v[96:99], a[152:155], a[44:47], v[96:99]
  s_waitcnt vmcnt(12)
  v_mfma_f32_16x16x32_bf16 v[100:103], a[156:159], a[44:47], v[100:103]
  s_waitcnt vmcnt(11)
  v_mfma_f32_16x16x32_bf16 v[104:107], a[160:163], a[44:47], v[104:107]
  s_waitcnt vmcnt(10)
  v_mfma_f32_16x16x32_bf16 v[136:139], a[212:215], a[80:83], v[136:139]
  buffer_load_dword v8, v41, s[20:23], 0 offen sc1
  v_mfma_f32_16x16x32_bf16 v[140:143], a[216:219], a[80:83], v[140:143]
  global_load_dwordx4 a[24:27], v2, s[20:21] offset:2048 sc1
  v_mfma_f32_16x16x32_bf16 v[144:147], a[220:223], a[80:83], v[144:147]
  v_mfma_f32_16x16x32_bf16 v[148:151], a[96:99], a[80:83], v[148:151]
  ds_write_b128 v49, v[88:91] offset:0
  v_mfma_f32_16x16x32_bf16 v[152:155], a[100:103], a[80:83], v[152:155]
  s_waitcnt vmcnt(10)
  global_load_dwordx4 a[28:31], v2, s[20:21] offset:3072 sc1
  v_mfma_f32_16x16x32_bf16 v[136:139], a[104:107], a[84:87], v[136:139]
  v_mfma_f32_16x16x32_bf16 v[140:143], a[108:111], a[84:87], v[140:143]
  ds_write_b128 v49, v[92:95] offset:1024
  v_mfma_f32_16x16x32_bf16 v[144:147], a[112:115], a[84:87], v[144:147]
  v_add_u32 v2, 8192, v2
  global_load_dwordx4 a[32:35], v2, s[20:21] offset:-4096 sc1
  v_mfma_f32_16x16x32_bf16 v[148:151], a[116:119], a[84:87], v[148:151]
  v_mfma_f32_16x16x32_bf16 v[152:155], a[120:123], a[84:87], v[152:155]
  s_waitcnt vmcnt(11)
  ds_write_b128 v49, v[96:99] offset:2048
  v_mfma_f32_16x16x32_bf16 v[136:139], a[124:127], a[88:91], v[136:139]
  global_load_dwordx4 a[36:39], v2, s[20:21] offset:-3072 sc1
  v_mfma_f32_16x16x32_bf16 v[140:143], a[128:131], a[88:91], v[140:143]
  v_mfma_f32_16x16x32_bf16 v[144:147], a[132:135], a[88:91], v[144:147]
  ds_write_b128 v49, v[100:103] offset:3072
  v_mfma_f32_16x16x32_bf16 v[148:151], a[136:139], a[88:91], v[148:151]
  v_mfma_f32_16x16x32_bf16 v[152:155], a[140:143], a[88:91], v[152:155]
  s_waitcnt vmcnt(11)
  global_load_dwordx4 a[40:43], v2, s[20:21] offset:-2048 sc1
  v_mfma_f32_16x16x32_bf16 v[136:139], a[144:147], a[92:95], v[136:139]
  ds_write_b128 v49, v[104:107] offset:4096
  v_mfma_f32_16x16x32_bf16 v[140:143], a[148:151], a[92:95], v[140:143]
  v_mfma_f32_16x16x32_bf16 v[144:147], a[152:155], a[92:95], v[144:147]
  global_load_dwordx4 a[44:47], v2, s[20:21] offset:-1024 sc1
  v_mfma_f32_16x16x32_bf16 v[148:151], a[156:159], a[92:95], v[148:151]
  v_mfma_f32_16x16x32_bf16 v[152:155], a[160:163], a[92:95], v[152:155]
  s_waitcnt vmcnt(12)
  v_mfma_f32_16x16x32_bf16 v[88:91], v[188:191], a[0:3], 0
  s_add_u32 m0, s17, 0
  v_add_u32 v0, s74, v4
  global_load_lds_dwordx4 v0, s[20:21] offset:0 sc1
  v_mfma_f32_16x16x32_bf16 v[92:95], v[192:195], a[0:3], 0
  v_mfma_f32_16x16x32_bf16 v[96:99], v[196:199], a[0:3], 0
  v_mfma_f32_16x16x32_bf16 v[100:103], v[200:203], a[0:3], 0
  ds_write_b128 v49, v[136:139] offset:20480
  v_mfma_f32_16x16x32_bf16 v[104:107], v[204:207], a[0:3], 0
  s_waitcnt vmcnt(12)
  global_load_lds_dwordx4 v0, s[20:21] offset:1024 sc1
  v_mfma_f32_16x16x32_bf16 v[88:91], v[208:211], a[4:7], v[88:91]
  v_mfma_f32_16x16x32_bf16 v[92:95], v[212:215], a[4:7], v[92:95]
  ds_write_b128 v49, v[140:143] offset:21504
  v_mfma_f32_16x16x32_bf16 v[96:99], v[216:219], a[4:7], v[96:99]
  global_load_lds_dwordx4 v0, s[20:21] offset:2048 sc1
  v_mfma_f32_16x16x32_bf16 v[100:103], v[220:223], a[4:7], v[100:103]
  v_mfma_f32_16x16x32_bf16 v[104:107], v[224:227], a[4:7], v[104:107]
  s_waitcnt vmcnt(13)
  ds_write_b128 v49, v[144:147] offset:22528
  v_mfma_f32_16x16x32_bf16 v[88:91], v[228:231], a[8:11], v[88:91]
  global_load_lds_dwordx4 v0, s[20:21] offset:3072 sc1
  v_mfma_f32_16x16x32_bf16 v[92:95], v[232:235], a[8:11], v[92:95]
  v_mfma_f32_16x16x32_bf16 v[96:99], v[236:239], a[8:11], v[96:99]
  ds_write_b128 v49, v[148:151] offset:23552
  v_mfma_f32_16x16x32_bf16 v[100:103], v[240:243], a[8:11], v[100:103]
  v_mfma_f32_16x16x32_bf16 v[104:107], v[244:247], a[8:11], v[104:107]
  s_waitcnt vmcnt(13)
  s_add_u32 m0, s17, 4096
  v_add_u32 v0, 4096, v0
  global_load_lds_dwordx4 v0, s[20:21] offset:0 sc1
  v_mfma_f32_16x16x32_bf16 v[88:91], v[248:251], a[12:15], v[88:91]
  ds_write_b128 v49, v[152:155] offset:24576
  v_mfma_f32_16x16x32_bf16 v[92:95], v[252:255], a[12:15], v[92:95]
  v_mfma_f32_16x16x32_bf16 v[96:99], v[160:163], a[12:15], v[96:99]
  v_mfma_f32_16x16x32_bf16 v[100:103], v[164:167], a[12:15], v[100:103]
  v_mfma_f32_16x16x32_bf16 v[104:107], v[168:171], a[12:15], v[104:107]
  s_waitcnt vmcnt(13)
  v_mfma_f32_16x16x32_bf16 v[88:91], v[172:175], a[16:19], v[88:91]
  v_mfma_f32_16x16x32_bf16 v[92:95], v[176:179], a[16:19], v[92:95]
  v_mfma_f32_16x16x32_bf16 v[96:99], v[180:183], a[16:19], v[96:99]
  v_mfma_f32_16x16x32_bf16 v[100:103], v[184:187], a[16:19], v[100:103]
  v_mfma_f32_16x16x32_bf16 v[104:107], a[240:243], a[16:19], v[104:107]
  s_waitcnt vmcnt(12)
  v_mfma_f32_16x16x32_bf16 v[88:91], a[244:247], a[20:23], v[88:91]
  v_mfma_f32_16x16x32_bf16 v[92:95], a[248:251], a[20:23], v[92:95]
  v_mfma_f32_16x16x32_bf16 v[96:99], a[252:255], a[20:23], v[96:99]
  v_mfma_f32_16x16x32_bf16 v[100:103], a[164:167], a[20:23], v[100:103]
  v_mfma_f32_16x16x32_bf16 v[104:107], a[168:171], a[20:23], v[104:107]
  s_waitcnt vmcnt(10)
  v_mfma_f32_16x16x32_bf16 v[88:91], a[172:175], a[24:27], v[88:91]
  v_cmp_gt_u32 vcc, 4, v8
  s_cbranch_vccnz slow_27
back_28:
  v_mfma_f32_16x16x32_bf16 v[92:95], a[176:179], a[24:27], v[92:95]
  v_add_u32 v2, 90112, v2
  global_load_dwordx4 a[48:51], v2, s[20:21] offset:-4096 sc1
  v_mfma_f32_16x16x32_bf16 v[96:99], a[180:183], a[24:27], v[96:99]
  v_mfma_f32_16x16x32_bf16 v[100:103], a[184:187], a[24:27], v[100:103]
  global_load_dwordx4 a[52:55], v2, s[20:21] offset:-3072 sc1
  v_mfma_f32_16x16x32_bf16 v[104:107], a[188:191], a[24:27], v[104:107]
  s_waitcnt vmcnt(11)
  v_mfma_f32_16x16x32_bf16 v[88:91], a[192:195], a[28:31], v[88:91]
  global_load_dwordx4 a[56:59], v2, s[20:21] offset:-2048 sc1
  v_mfma_f32_16x16x32_bf16 v[92:95], a[196:199], a[28:31], v[92:95]
  v_mfma_f32_16x16x32_bf16 v[96:99], a[200:203], a[28:31], v[96:99]
  global_load_dwordx4 a[60:63], v2, s[20:21] offset:-1024 sc1
  v_mfma_f32_16x16x32_bf16 v[100:103], a[204:207], a[28:31], v[100:103]
  v_mfma_f32_16x16x32_bf16 v[104:107], a[208:211], a[28:31], v[104:107]
  s_waitcnt vmcnt(12)
  global_load_dwordx4 a[64:67], v2, s[20:21] offset:0 sc1
  v_mfma_f32_16x16x32_bf16 v[88:91], a[212:215], a[32:35], v[88:91]
  v_mfma_f32_16x16x32_bf16 v[92:95], a[216:219], a[32:35], v[92:95]
  global_load_dwordx4 a[68:71], v2, s[20:21] offset:1024 sc1
  v_mfma_f32_16x16x32_bf16 v[96:99], a[220:223], a[32:35], v[96:99]
  v_mfma_f32_16x16x32_bf16 v[100:103], a[96:99], a[32:35], v[100:103]
  global_load_dwordx4 a[72:75], v2, s[20:21] offset:2048 sc1
  v_mfma_f32_16x16x32_bf16 v[104:107], a[100:103], a[32:35], v[104:107]
  s_waitcnt vmcnt(14)
  v_mfma_f32_16x16x32_bf16 v[88:91], a[104:107], a[36:39], v[88:91]
  global_load_dwordx4 a[76:79], v2, s[20:21] offset:3072 sc1
  v_mfma_f32_16x16x32_bf16 v[92:95], a[108:111], a[36:39], v[92:95]
  v_mfma_f32_16x16x32_bf16 v[96:99], a[112:115], a[36:39], v[96:99]
  v_add_u32 v2, 8192, v2
  global_load_dwordx4 a[80:83], v2, s[20:21] offset:-4096 sc1
  v_mfma_f32_16x16x32_bf16 v[100:103], a[116:119], a[36:39], v[100:103]
  v_mfma_f32_16x16x32_bf16 v[104:107], a[120:123], a[36:39], v[104:107]
  s_waitcnt vmcnt(15)
  global_load_dwordx4 a[84:87], v2, s[20:21] offset:-3072 sc1
  v_mfma_f32_16x16x32_bf16 v[88:91], a[124:127], a[40:43], v[88:91]
  v_mfma_f32_16x16x32_bf16 v[92:95], a[128:131], a[40:43], v[92:95]
  global_load_dwordx4 a[88:91], v2, s[20:21] offset:-2048 sc1
  v_mfma_f32_16x16x32_bf16 v[96:99], a[132:135], a[40:43], v[96:99]
  v_mfma_f32_16x16x32_bf16 v[100:103], a[136:139], a[40:43], v[100:103]
  global_load_dwordx4 a[92:95], v2, s[20:21] offset:-1024 sc1
  v_mfma_f32_16x16x32_bf16 v[104:107], a[140:143], a[40:43], v[104:107]
  s_waitcnt vmcnt(17)
  v_mfma_f32_16x16x32_bf16 v[88:91], a[144:147], a[44:47], v[88:91]
  v_mfma_f32_16x16x32_bf16 v[92:95], a[148:151], a[44:47], v[92:95]
  v_mfma_f32_16x16x32_bf16 v[96:99], a[152:155], a[44:47], v[96:99]
  v_mfma_f32_16x16x32_bf16 v[100:103], a[156:159], a[44:47], v[100:103]
  v_mfma_f32_16x16x32_bf16 v[104:107], a[160:163], a[44:47], v[104:107]
  s_waitcnt vmcnt(11)
  v_mfma_f32_16x16x32_bf16 v[136:139], v[188:191], a[48:51], 0
  v_mfma_f32_16x16x32_bf16 v[140:143], v[192:195], a[48:51], 0
  v_mfma_f32_16x16x32_bf16 v[144:147], v[196:199], a[48:51], 0
  v_mfma_f32_16x16x32_bf16 v[148:151], v[200:203], a[48:51], 0
  ds_write_b128 v50, v[88:91] offset:0
  v_mfma_f32_16x16x32_bf16 v[152:155], v[204:207], a[48:51], 0
  s_waitcnt vmcnt(10)
  v_mfma_f32_16x16x32_bf16 v[136:139], v[208:211], a[52:55], v[136:139]
  v_mfma_f32_16x16x32_bf16 v[140:143], v[212:215], a[52:55], v[140:143]
  ds_write_b128 v50, v[92:95] offset:1024
  v_mfma_f32_16x16x32_bf16 v[144:147], v[216:219], a[52:55], v[144:147]
  v_mfma_f32_16x16x32_bf16 v[148:151], v[220:223], a[52:55], v[148:151]
  v_mfma_f32_16x16x32_bf16 v[152:155], v[224:227], a[52:55], v[152:155]
  s_waitcnt vmcnt(9)
  ds_write_b128 v50, v[96:99] offset:2048
  v_mfma_f32_16x16x32_bf16 v[136:139], v[228:231], a[56:59], v[136:139]
  v_mfma_f32_16x16x32_bf16 v[140:143], v[232:235], a[56:59], v[140:143]
  v_mfma_f32_16x16x32_bf16 v[144:147], v[236:239], a[56:59], v[144:147]
  ds_write_b128 v50, v[100:103] offset:3072
  v_mfma_f32_16x16x32_bf16 v[148:151], v[240:243], a[56:59], v[148:151]
  v_mfma_f32_16x16x32_bf16 v[152:155], v[244:247], a[56:59], v[152:155]
  s_waitcnt vmcnt(8)
  v_mfma_f32_16x16x32_bf16 v[136:139], v[248:251], a[60:63], v[136:139]
  ds_write_b128 v50, v[104:107] offset:4096
  v_mfma_f32_16x16x32_bf16 v[140:143], v[252:255], a[60:63], v[140:143]
  v_mfma_f32_16x16x32_bf16 v[144:147], v[160:163], a[60:63], v[144:147]
  v_mfma_f32_16x16x32_bf16 v[148:151], v[164:167], a[60:63], v[148:151]
  v_mfma_f32_16x16x32_bf16 v[152:155], v[168:171], a[60:63], v[152:155]
  s_waitcnt vmcnt(7)
  v_mfma_f32_16x16x32_bf16 v[136:139], v[172:175], a[64:67], v[136:139]
  v_mfma_f32_16x16x32_bf16 v[140:143], v[176:179], a[64:67], v[140:143]
  v_mfma_f32_16x16x32_bf16 v[144:147], v[180:183], a[64:67], v[144:147]
  v_mfma_f32_16x16x32_bf16 v[148:151], v[184:187], a[64:67], v[148:151]
  v_mfma_f32_16x16x32_bf16 v[152:155], a[240:243], a[64:67], v[152:155]
  s_waitcnt vmcnt(6)
  v_mfma_f32_16x16x32_bf16 v[136:139], a[244:247], a[68:71], v[136:139]
  v_mfma_f32_16x16x32_bf16 v[140:143], a[248:251], a[68:71], v[140:143]
  v_mfma_f32_16x16x32_bf16 v[144:147], a[252:255], a[68:71], v[144:147]
  v_mfma_f32_16x16x32_bf16 v[148:151], a[164:167], a[68:71], v[148:151]
  v_mfma_f32_16x16x32_bf16 v[152:155], a[168:171], a[68:71], v[152:155]
  s_waitcnt vmcnt(5)
  v_mfma_f32_16x16x32_bf16 v[136:139], a[172:175], a[72:75], v[136:139]
  v_mfma_f32_16x16x32_bf16 v[140:143], a[176:179], a[72:75], v[140:143]
  v_mfma_f32_16x16x32_bf16 v[144:147], a[180:183], a[72:75], v[144:147]
  v_mfma_f32_16x16x32_bf16 v[148:151], a[184:187], a[72:75], v[148:151]
  v_mfma_f32_16x16x32_bf16 v[152:155], a[188:191], a[72:75], v[152:155]
  s_waitcnt vmcnt(4)
  v_mfma_f32_16x16x32_bf16 v[136:139], a[192:195], a[76:79], v[136:139]
  v_mfma_f32_16x16x32_bf16 v[140:143], a[196:199], a[76:79], v[140:143]
  v_mfma_f32_16x16x32_bf16 v[144:147], a[200:203], a[76:79], v[144:147]
  v_mfma_f32_16x16x32_bf16 v[148:151], a[204:207], a[76:79], v[148:151]
  v_mfma_f32_16x16x32_bf16 v[152:155], a[208:211], a[76:79], v[152:155]
  s_waitcnt vmcnt(3)
  v_mfma_f32_16x16x32_bf16 v[136:139], a[212:215], a[80:83], v[136:139]
  v_mfma_f32_16x16x32_bf16 v[140:143], a[216:219], a[80:83], v[140:143]
  v_mfma_f32_16x16x32_bf16 v[144:147], a[220:223], a[80:83], v[144:147]
  ds_read_b64_tr_b16 v[10:11], v42 offset:0
  v_mfma_f32_16x16x32_bf16 v[148:151], a[96:99], a[80:83], v[148:151]
  v_mfma_f32_16x16x32_bf16 v[152:155], a[100:103], a[80:83], v[152:155]
  s_waitcnt vmcnt(2)
  ds_read_b64_tr_b16 v[12:13], v42 offset:1024
  v_mfma_f32_16x16x32_bf16 v[136:139], a[104:107], a[84:87], v[136:139]
  v_mfma_f32_16x16x32_bf16 v[140:143], a[108:111], a[84:87], v[140:143]
  ds_read_b64_tr_b16 v[14:15], v42 offset:2048
  v_mfma_f32_16x16x32_bf16 v[144:147], a[112:115], a[84:87], v[144:147]
  v_mfma_f32_16x16x32_bf16 v[148:151], a[116:119], a[84:87], v[148:151]
  ds_read_b64_tr_b16 v[16:17], v42 offset:3072
  v_mfma_f32_16x16x32_bf16 v[152:155], a[120:123], a[84:87], v[152:155]
  s_waitcnt vmcnt(1)
  v_mfma_f32_16x16x32_bf16 v[136:139], a[124:127], a[88:91], v[136:139]
  ds_read_b64_tr_b16 v[18:19], v42 offset:4096
  v_mfma_f32_16x16x32_bf16 v[140:143], a[128:131], a[88:91], v[140:143]
  v_mfma_f32_16x16x32_bf16 v[144:147], a[132:135], a[88:91], v[144:147]
  v_mfma_f32_16x16x32_bf16 v[148:151], a[136:139], a[88:91], v[148:151]
  v_mfma_f32_16x16x32_bf16 v[152:155], a[140:143], a[88:91], v[152:155]
  s_waitcnt vmcnt(0)
  v_mfma_f32_16x16x32_bf16 v[136:139], a[144:147], a[92:95], v[136:139]
  v_mfma_f32_16x16x32_bf16 v[140:143], a[148:151], a[92:95], v[140:143]
  v_mfma_f32_16x16x32_bf16 v[144:147], a[152:155], a[92:95], v[144:147]
  v_mfma_f32_16x16x32_bf16 v[148:151], a[156:159], a[92:95], v[148:151]
  v_mfma_f32_16x16x32_bf16 v[152:155], a[160:163], a[92:95], v[152:155]
  s_nop 3
  ds_write_b128 v50, v[136:139] offset:20480
  ds_write_b128 v50, v[140:143] offset:21504
  ds_write_b128 v50, v[144:147] offset:22528
  ds_write_b128 v50, v[148:151] offset:23552
  ds_write_b128 v50, v[152:155] offset:24576
  s_waitcnt lgkmcnt(0)
  s_barrier
  ds_read_b128 v[56:59], v51 offset:0
  ds_read_b128 v[60:63], v51 offset:5120
  ds_read_b128 v[64:67], v51 offset:10240
  ds_read_b128 v[68:71], v51 offset:15360
  ds_read_b128 v[72:75], v51 offset:1024
  ds_read_b128 v[76:79], v51 offset:6144
  ds_read_b128 v[80:83], v51 offset:11264
  ds_read_b128 v[84:87], v51 offset:16384
  ds_read_b128 v[88:91], v51 offset:2048
  ds_read_b128 v[92:95], v51 offset:7168
  ds_read_b128 v[96:99], v51 offset:12288
  ds_read_b128 v[100:103], v51 offset:17408
  ds_read_b128 v[104:107], v51 offset:3072
  ds_read_b128 v[108:111], v51 offset:8192
  ds_read_b128 v[112:115], v51 offset:13312
  ds_read_b128 v[116:119], v51 offset:18432
  ds_read_b128 v[120:123], v51 offset:4096
  ds_read_b128 v[124:127], v51 offset:9216
  ds_read_b128 v[128:131], v51 offset:14336
  ds_read_b128 v[132:135], v51 offset:19456
  v_lshlrev_b32 v140, 16, v10
  v_and_b32 v141, 0xffff0000, v10
  v_lshlrev_b32 v142, 16, v11
  v_and_b32 v143, 0xffff0000, v11
  v_lshlrev_b32 v144, 16, v12
  v_and_b32 v145, 0xffff0000, v12
  v_lshlrev_b32 v146, 16, v13
  v_and_b32 v147, 0xffff0000, v13
  v_lshlrev_b32 v148, 16, v14
  v_and_b32 v149, 0xffff0000, v14
  v_lshlrev_b32 v150, 16, v15
  v_and_b32 v151, 0xffff0000, v15
  v_lshlrev_b32 v152, 16, v16
  v_and_b32 v153, 0xffff0000, v16
  v_lshlrev_b32 v154, 16, v17
  v_and_b32 v155, 0xffff0000, v17
  v_lshlrev_b32 v156, 16, v18
  v_and_b32 v157, 0xffff0000, v18
  v_lshlrev_b32 v158, 16, v19
  v_and_b32 v159, 0xffff0000, v19
  s_waitcnt lgkmcnt(14)
  v_pk_add_f32 v[56:57], v[56:57], v[60:61]
  v_pk_add_f32 v[64:65], v[64:65], v[68:69]
  v_pk_add_f32 v[58:59], v[58:59], v[62:63]
  v_pk_add_f32 v[66:67], v[66:67], v[70:71]
  v_pk_add_f32 v[56:57], v[56:57], v[140:141]
  v_pk_add_f32 v[58:59], v[58:59], v[142:143]
  v_pk_add_f32 v[56:57], v[56:57], v[64:65]
  v_pk_add_f32 v[58:59], v[58:59], v[66:67]
  v_cvt_pk_bf16_f32 v20, v56, v57
  v_cvt_pk_bf16_f32 v21, v58, v59
  s_waitcnt lgkmcnt(12)
  v_pk_add_f32 v[72:73], v[72:73], v[76:77]
  v_pk_add_f32 v[80:81], v[80:81], v[84:85]
  v_pk_add_f32 v[74:75], v[74:75], v[78:79]
  v_pk_add_f32 v[82:83], v[82:83], v[86:87]
  v_pk_add_f32 v[72:73], v[72:73], v[144:145]
  v_pk_add_f32 v[74:75], v[74:75], v[146:147]
  v_pk_add_f32 v[72:73], v[72:73], v[80:81]
  v_pk_add_f32 v[74:75], v[74:75], v[82:83]
  v_cvt_pk_bf16_f32 v22, v72, v73
  v_cvt_pk_bf16_f32 v23, v74, v75
  s_nop 0
  v_permlane16_swap_b32 v20, v22
  v_permlane16_swap_b32 v21, v23
  buffer_store_dwordx4 v[20:23], v43, s[44:47], s69 offen offset:0
  s_waitcnt lgkmcnt(8)
  v_pk_add_f32 v[88:89], v[88:89], v[92:93]
  v_pk_add_f32 v[96:97], v[96:97], v[100:101]
  v_pk_add_f32 v[90:91], v[90:91], v[94:95]
  v_pk_add_f32 v[98:99], v[98:99], v[102:103]
  v_pk_add_f32 v[88:89], v[88:89], v[148:149]
  v_pk_add_f32 v[90:91], v[90:91], v[150:151]
  v_pk_add_f32 v[88:89], v[88:89], v[96:97]
  v_pk_add_f32 v[90:91], v[90:91], v[98:99]
  v_cvt_pk_bf16_f32 v24, v88, v89
  v_cvt_pk_bf16_f32 v25, v90, v91
  s_waitcnt lgkmcnt(4)
  v_pk_add_f32 v[104:105], v[104:105], v[108:109]
  v_pk_add_f32 v[112:113], v[112:113], v[116:117]
  v_pk_add_f32 v[106:107], v[106:107], v[110:111]
  v_pk_add_f32 v[114:115], v[114:115], v[118:119]
  v_pk_add_f32 v[104:105], v[104:105], v[152:153]
  v_pk_add_f32 v[106:107], v[106:107], v[154:155]
  v_pk_add_f32 v[104:105], v[104:105], v[112:113]
  v_pk_add_f32 v[106:107], v[106:107], v[114:115]
  v_cvt_pk_bf16_f32 v26, v104, v105
  v_cvt_pk_bf16_f32 v27, v106, v107
  s_nop 0
  v_permlane16_swap_b32 v24, v26
  v_permlane16_swap_b32 v25, v27
  buffer_store_dwordx4 v[24:27], v43, s[44:47], s69 offen offset:64
  s_waitcnt lgkmcnt(0)
  v_pk_add_f32 v[120:121], v[120:121], v[124:125]
  v_pk_add_f32 v[128:129], v[128:129], v[132:133]
  v_pk_add_f32 v[122:123], v[122:123], v[126:127]
  v_pk_add_f32 v[130:131], v[130:131], v[134:135]
  v_pk_add_f32 v[120:121], v[120:121], v[156:157]
  v_pk_add_f32 v[122:123], v[122:123], v[158:159]
  v_pk_add_f32 v[120:121], v[120:121], v[128:129]
  v_pk_add_f32 v[122:123], v[122:123], v[130:131]
  v_cvt_pk_bf16_f32 v28, v120, v121
  v_cvt_pk_bf16_f32 v29, v122, v123
  buffer_store_dwordx2 v[28:29], v48, s[44:47], s69 offen
  s_endpgm
L_LAST:
slow_5:
  s_mov_b32 s73, 0x40000
sp_29:
  global_load_dword v8, v204, s[4:5] sc1
  s_waitcnt vmcnt(0)
  v_cmp_gt_u32 vcc, 8, v8
  s_cbranch_vccz back_6
  s_sleep 1
  s_sub_u32 s73, s73, 1
  s_cmp_lg_u32 s73, 0
  s_cbranch_scc1 sp_29
  s_branch back_6
slow_9:
  s_mov_b32 s73, 0x40000
sp_30:
  buffer_load_dword v8, v6, s[20:23], 0 offen offset:0 sc1
  s_waitcnt vmcnt(0)
  v_cmp_ne_u32 vcc, 16, v8
  s_cbranch_vccz back_10
  s_sleep 1
  s_sub_u32 s73, s73, 1
  s_cmp_lg_u32 s73, 0
  s_cbranch_scc1 sp_30
  s_branch back_10
slow_13:
  s_mov_b32 s73, 0x40000
sp_31:
  buffer_load_dword v8, v6, s[20:23], 0 offen offset:256 sc1
  s_waitcnt vmcnt(0)
  v_cmp_ne_u32 vcc, 16, v8
  s_cbranch_vccz back_14
  s_sleep 1
  s_sub_u32 s73, s73, 1
  s_cmp_lg_u32 s73, 0
  s_cbranch_scc1 sp_31
  s_branch back_14
slow_17:
  s_mov_b32 s73, 0x40000
sp_32:
  buffer_load_dword v8, v6, s[20:23], 0 offen offset:512 sc1
  s_waitcnt vmcnt(0)
  v_cmp_ne_u32 vcc, 16, v8
  s_cbranch_vccz back_18
  s_sleep 1
  s_sub_u32 s73, s73, 1
  s_cmp_lg_u32 s73, 0
  s_cbranch_scc1 sp_32
  s_branch back_18
slow_19:
  s_mov_b32 s73, 0x40000
sp_33:
  buffer_load_dword v8, v6, s[20:23], 0 offen offset:768 sc1
  s_waitcnt vmcnt(0)
  v_cmp_ne_u32 vcc, 16, v8
  s_cbranch_vccz back_20
  s_sleep 1
  s_sub_u32 s73, s73, 1
  s_cmp_lg_u32 s73, 0
  s_cbranch_scc1 sp_33
  s_branch back_20
slow_21:
  s_mov_b32 s73, 0x40000
sp_34:
  buffer_load_dword v8, v41, s[20:23], 0 offen sc1
  s_waitcnt vmcnt(0)
  v_cmp_gt_u32 vcc, 1, v8
  s_cbranch_vccz back_22
  s_sleep 1
  s_sub_u32 s73, s73, 1
  s_cmp_lg_u32 s73, 0
  s_cbranch_scc1 sp_34
  s_branch back_22
slow_23:
  s_mov_b32 s73, 0x40000
sp_35:
  buffer_load_dword v8, v41, s[20:23], 0 offen sc1
  s_waitcnt vmcnt(0)
  v_cmp_gt_u32 vcc, 2, v8
  s_cbranch_vccz back_24
  s_sleep 1
  s_sub_u32 s73, s73, 1
  s_cmp_lg_u32 s73, 0
  s_cbranch_scc1 sp_35
  s_branch back_24
slow_25:
  s_mov_b32 s73, 0x40000
sp_36:
  buffer_load_dword v8, v41, s[20:23], 0 offen sc1
  s_waitcnt vmcnt(0)
  v_cmp_gt_u32 vcc, 3, v8
  s_cbranch_vccz back_26
  s_sleep 1
  s_sub_u32 s73, s73, 1
  s_cmp_lg_u32 s73, 0
  s_cbranch_scc1 sp_36
  s_branch back_26
slow_27:
  s_mov_b32 s73, 0x40000
sp_37:
  buffer_load_dword v8, v41, s[20:23], 0 offen sc1
  s_waitcnt vmcnt(0)
  v_cmp_gt_u32 vcc, 4, v8
  s_cbranch_vccz back_28
  s_sleep 1
  s_sub_u32 s73, s73, 1
  s_cmp_lg_u32 s73, 0
  s_cbranch_scc1 sp_37
  s_branch back_28
L_END:
  s_endpgm
.section .rodata,"a"
.p2align 6
.amdhsa_kernel sequential_preLN__ssm_conv_h3__glu_gated_swiglu__prompt_kernel
  .amdhsa_next_free_vgpr 512
  .amdhsa_next_free_sgpr 102
  .amdhsa_accum_offset 256
  .amdhsa_group_segment_fixed_size 0
  .amdhsa_kernarg_size 104
  .amdhsa_user_sgpr_count 2
  .amdhsa_user_sgpr_kernarg_segment_ptr 1
  .amdhsa_system_sgpr_workgroup_id_x 1
  .amdhsa_float_denorm_mode_32 3
.end_amdhsa_kernel
```
